```python
import torch

def _softmax(x, axis=-1):
    return torch.softmax(x, dim=axis)
def _gelu(x):
    return torch.nn.functional.gelu(x, approximate="tanh")
def _silu(x):
    return torch.nn.functional.silu(x)
def _sigmoid(x):
    return torch.sigmoid(x)
def _layernorm(x, axis=-1, eps=1e-5):
    m = x.mean(dim=axis, keepdim=True)
    v = x.var(dim=axis, keepdim=True, unbiased=False)
    return (x - m) / torch.sqrt(v + eps)
def _scatter_add(tgt, idx, src, axis=0):
    return tgt.clone().index_add_(axis, idx, src)
def _segment_sum(src, seg, n):
    out = torch.zeros((n,) + src.shape[1:], dtype=src.dtype)
    return out.index_add_(0, seg, src)
def _pad(x, pw):
    flat = tuple(v for pair in reversed(pw) for v in pair)
    return torch.nn.functional.pad(x, flat)

kernel_name = 'recurrent_scan__sliding_block_cached__mixer_channel_mlp__decode'

def setup_inputs():

    _w = (lambda a: (lambda t: t.to(torch.bfloat16) if t.is_floating_point() else t)(torch.as_tensor(a)))
    def _A_setup():
        B, Sq, D = 4, 1, 512
        Hq, Hkv, Sk, Dh = 32, 8, 8192, 128
        assert Hq % Hkv == 0, (Hq, Hkv)
        return {
            "x": _w((lambda *s: torch.randn(*s, dtype=torch.bfloat16) * 0.05)(B, Sq, D)),
            "k_cache": _w((lambda *s: torch.randn(*s, dtype=torch.bfloat16) * 3.2)(B, Hkv, Sk, Dh)),
            "v_cache": _w((lambda *s: torch.randn(*s, dtype=torch.bfloat16) * 3.2)(B, Hkv, Sk, Dh)),
            "wq": _w((lambda *s: torch.randn(*s, dtype=torch.bfloat16) * 3.2)(D, Hq * Dh) * (D ** -0.5)),
            "wo": _w((lambda *s: torch.randn(*s, dtype=torch.bfloat16) * 3.2)(Hq * Dh, D) * ((Hq * Dh) ** -0.5)),
        }
    _A_in = _A_setup()

    def _B_setup():
        B, S, D, F = 4, 1, 512, 1792
        return {
            "x": _w((lambda *s: torch.randn(*s, dtype=torch.bfloat16) * 0.05)(B, S, D)),
            "w1": _w((lambda *s: torch.randn(*s, dtype=torch.bfloat16) * 3.2)(D, F) * (D ** -0.5)),
            "b1": _w((lambda *s: torch.randn(*s, dtype=torch.bfloat16) * 3.2)(F)),
            "w2": _w((lambda *s: torch.randn(*s, dtype=torch.bfloat16) * 3.2)(F, D) * (F ** -0.5)),
            "b2": _w((lambda *s: torch.randn(*s, dtype=torch.bfloat16) * 3.2)(D)),
        }
    _B_in = _B_setup()

    return {
        "A_x": _A_in["x"],
        "A_k_cache": _A_in["k_cache"],
        "A_v_cache": _A_in["v_cache"],
        "A_wq": _A_in["wq"],
        "A_wo": _A_in["wo"],
        "B_x": _B_in["x"],
        "B_w1": _B_in["w1"],
        "B_b1": _B_in["b1"],
        "B_w2": _B_in["w2"],
        "B_b2": _B_in["b2"],
    }

def reference(A_x, A_k_cache, A_v_cache, A_wq, A_wo, B_x, B_w1, B_b1, B_w2, B_b2):
    def _A_ref(x, k_cache, v_cache, wq, wo):
        B, Sq, D = x.shape
        Hq, Dh = 32, 128
        Hkv, Sk = k_cache.shape[1], k_cache.shape[2]
        W = min(4096, max(256, Sk // 4))
        rep = Hq // Hkv
        q = (lambda x, *d: x.permute(*d))((x @ wq).reshape(B, Sq, Hq, Dh), 0, 2, 1, 3)
        k = (lambda x, n, axis: torch.repeat_interleave(x, n, dim=axis))(k_cache[:, :, Sk - W:, :], rep, axis=1)
        v = (lambda x, n, axis: torch.repeat_interleave(x, n, dim=axis))(v_cache[:, :, Sk - W:, :], rep, axis=1)
        scores = torch.einsum("bhqd,bhkd->bhqk", q, k) * (Dh ** -0.5)
        p = _softmax(scores, axis=-1)
        o = torch.einsum("bhqk,bhkd->bhqd", p, v)
        return (lambda x, *d: x.permute(*d))(o, 0, 2, 1, 3).reshape(B, Sq, Hq * Dh) @ wo

    def _B_ref(x, w1, b1, w2, b2):
        y = _layernorm(x, axis=-1)
        h = _gelu(torch.einsum("bsd,df->bsf", y, w1) + b1)
        return torch.einsum("bsf,fd->bsd", h, w2) + b2

    x = A_x
    xn = _layernorm(x, axis=-1)
    s = _A_ref(xn, A_k_cache, A_v_cache, A_wq, A_wo)
    g = _silu(_B_ref(xn, B_w1, B_b1, B_w2, B_b2))
    return x + s * g
```

```asm
; @launch grid=(256,1,1) block=(768,1,1) lds=66304
.amdgcn_target "amdgcn-amd-amdhsa--gfx950"
.text
.globl recurrent_scan__sliding_block_cached__mixer_channel_mlp__decode_kernel
.p2align 8
.type recurrent_scan__sliding_block_cached__mixer_channel_mlp__decode_kernel,@function
recurrent_scan__sliding_block_cached__mixer_channel_mlp__decode_kernel:
    s_cmp_ge_u32 s2, 256
    s_cbranch_scc1 L_end
    s_load_dwordx16 s[36:51], s[0:1], 0
    s_load_dwordx8 s[52:59], s[0:1], 64
    s_load_dwordx2 s[60:61], s[0:1], 96
    v_lshrrev_b32 v1, 6, v0
    v_and_b32 v0, 63, v0
    v_readfirstlane_b32 s3, v1
    s_and_b32 s4, s2, 7
    s_lshr_b32 s5, s2, 3
    s_lshr_b32 s7, s5, 3
    s_and_b32 s8, s5, 7
    s_and_b32 s6, s3, 3
    s_cmp_lt_u32 s3, 4
    s_cbranch_scc1 L_V
    s_cmp_lt_u32 s3, 8
    s_cbranch_scc0 L_K
    s_setprio 3
    s_lshl_b32 s13, s4, 5
    s_add_u32 s13, s13, s5
    v_mov_b32 v4, 0
    s_cmp_eq_u32 s6, 0
    s_cbranch_scc1 L_C0
    s_lshl_b32 s14, s4, 2
    s_lshr_b32 s15, 0x44044444, s14
    s_and_b32 s15, s15, 15
    s_lshl_b32 s15, s15, 2
    s_mov_b32 s16, 0x18141410
    s_cmp_lt_u32 s4, 4
    s_cselect_b32 s16, 0xc080400, s16
    s_and_b32 s14, s4, 3
    s_lshl_b32 s14, s14, 3
    s_lshr_b32 s16, s16, s14
    s_and_b32 s16, s16, 0xff
    s_lshl_b32 s16, s16, 2
    s_add_u32 s12, s16, s5
    s_cmp_eq_u32 s6, 1
    s_cbranch_scc0 L_C23
    s_cmp_lt_u32 s5, s15
    s_cbranch_scc1 L_C1
L_C23:
    s_getpc_b64 s[18:19]
L_pc:
    s_sub_u32 s18, s18, L_pc-recurrent_scan__sliding_block_cached__mixer_channel_mlp__decode_kernel
    s_subb_u32 s19, s19, 0
    s_lshl_b32 s14, s5, 10
    v_lshlrev_b32 v8, 4, v0
    v_add_u32 v8, s14, v8
    v_cmp_gt_u32 vcc, L_code_end-recurrent_scan__sliding_block_cached__mixer_channel_mlp__decode_kernel-16, v8
    s_cmp_eq_u32 s6, 3
    s_nop 0
    s_cselect_b64 vcc, vcc, 0
    s_and_saveexec_b64 s[20:21], vcc
    s_cbranch_execz L_nopf
    global_load_dwordx4 v[8:11], v8, s[18:19]
L_nopf:
    s_mov_b64 exec, -1
    s_waitcnt lgkmcnt(0)
    s_load_dword s9, s[60:61], 49152
    s_waitcnt lgkmcnt(0)
    s_mul_i32 s9, s9, 0x915f77f5
    s_add_u32 s9, s9, 0x3c6ef35d
    s_or_b32 s9, s9, 1
    s_branch L_CF
L_C0:
    s_mov_b32 s24, s7
    s_lshl_b32 s25, s4, 10
    s_lshl_b32 s26, s8, 7
    s_add_u32 s25, s25, s26
    s_lshl_b32 s26, s4, 3
    s_add_u32 s26, s26, s8
    s_lshl_b32 s26, s26, 2
    s_add_u32 s26, s26, s7
    v_lshrrev_b32 v5, 3, v0
    v_and_b32 v6, 7, v0
    s_lshl_b32 s10, s24, 7
    v_add_u32 v14, s10, v5
    v_mul_u32_u24 v14, 8192, v14
    v_lshl_add_u32 v14, v6, 4, v14
    v_add_u32 v14, s25, v14
    s_waitcnt lgkmcnt(0)
    s_load_dword s9, s[60:61], 49152
    global_load_dwordx4 v[96:99], v14, s[42:43] nt
    v_add_u32 v14, 0x10000, v14
    global_load_dwordx4 v[100:103], v14, s[42:43] nt
    v_add_u32 v14, 0x10000, v14
    global_load_dwordx4 v[104:107], v14, s[42:43] nt
    v_add_u32 v14, 0x10000, v14
    global_load_dwordx4 v[108:111], v14, s[42:43] nt
    v_add_u32 v14, 0x10000, v14
    global_load_dwordx4 v[112:115], v14, s[42:43] nt
    v_add_u32 v14, 0x10000, v14
    global_load_dwordx4 v[116:119], v14, s[42:43] nt
    v_add_u32 v14, 0x10000, v14
    global_load_dwordx4 v[120:123], v14, s[42:43] nt
    v_add_u32 v14, 0x10000, v14
    global_load_dwordx4 v[124:127], v14, s[42:43] nt
    v_add_u32 v14, 0x10000, v14
    global_load_dwordx4 v[128:131], v14, s[42:43] nt
    v_add_u32 v14, 0x10000, v14
    global_load_dwordx4 v[132:135], v14, s[42:43] nt
    v_add_u32 v14, 0x10000, v14
    global_load_dwordx4 v[136:139], v14, s[42:43] nt
    v_add_u32 v14, 0x10000, v14
    global_load_dwordx4 v[140:143], v14, s[42:43] nt
    v_add_u32 v14, 0x10000, v14
    global_load_dwordx4 v[144:147], v14, s[42:43] nt
    v_add_u32 v14, 0x10000, v14
    global_load_dwordx4 v[148:151], v14, s[42:43] nt
    v_add_u32 v14, 0x10000, v14
    global_load_dwordx4 v[152:155], v14, s[42:43] nt
    v_add_u32 v14, 0x10000, v14
    global_load_dwordx4 v[156:159], v14, s[42:43] nt
    v_bfe_u32 v7, v5, 1, 2
    v_lshlrev_b32 v7, 1, v7
    v_xor_b32 v7, v7, v6
    v_lshlrev_b32 v7, 4, v7
    v_lshl_add_u32 v7, v5, 7, v7
    v_lshrrev_b32 v5, 2, v0
    v_bfe_u32 v6, v0, 1, 1
    v_bfe_u32 v14, v5, 1, 2
    v_lshlrev_b32 v14, 1, v14
    v_or_b32 v6, v6, v14
    v_lshlrev_b32 v6, 4, v6
    v_and_b32 v14, 1, v0
    v_lshl_add_u32 v6, v14, 3, v6
    v_lshl_add_u32 v20, v5, 7, v6
    v_xor_b32 v21, 32, v20
    v_xor_b32 v22, 64, v20
    v_xor_b32 v23, 0x60, v20
    v_and_b32 v5, 3, v0
    v_lshlrev_b32 v5, 10, v5
    v_lshrrev_b32 v14, 4, v0
    v_lshl_add_u32 v5, v14, 4, v5
    s_lshl_b32 s10, s24, 8
    v_add_u32 v5, s10, v5
    v_cmp_eq_u32 s[18:19], 1, v14
    v_cmp_eq_u32 s[20:21], 2, v14
    v_cmp_eq_u32 s[22:23], 3, v14
    v_lshlrev_b32 v6, 2, v0
    v_cmp_le_u32 vcc, 22, v0
    s_nop 1
    v_cndmask_b32 v15, 0, 1, vcc
    v_mul_u32_u24 v16, 22, v15
    v_sub_u32 v16, v0, v16
    v_min_u32 v16, 21, v16
    v_mul_u32_u24 v17, 272, v15
    v_mul_u32_u24 v18, 12, v16
    v_add_u32 v17, v17, v18
    s_mul_i32 s10, s26, 1536
    s_add_u32 s10, s10, 262144
    v_mul_u32_u24 v18, 384, v15
    v_lshl_add_u32 v18, v16, 4, v18
    v_add_u32 v18, s10, v18
    s_waitcnt lgkmcnt(0)
    s_mul_i32 s9, s9, 0x915f77f5
    s_add_u32 s9, s9, 0x3c6ef35d
    s_or_b32 s9, s9, 1
    s_waitcnt vmcnt(15)
    ds_write_b128 v7, v[96:99] offset:25344
    s_waitcnt vmcnt(14)
    ds_write_b128 v7, v[100:103] offset:26368
    s_waitcnt vmcnt(13)
    ds_write_b128 v7, v[104:107] offset:27392
    s_waitcnt vmcnt(12)
    ds_write_b128 v7, v[108:111] offset:28416
    s_waitcnt vmcnt(11)
    ds_write_b128 v7, v[112:115] offset:29440
    s_waitcnt vmcnt(10)
    ds_write_b128 v7, v[116:119] offset:30464
    s_waitcnt vmcnt(9)
    ds_write_b128 v7, v[120:123] offset:31488
    s_waitcnt vmcnt(8)
    ds_write_b128 v7, v[124:127] offset:32512
    s_waitcnt vmcnt(7)
    ds_write_b128 v7, v[128:131] offset:33536
    s_waitcnt vmcnt(6)
    ds_write_b128 v7, v[132:135] offset:34560
    s_waitcnt vmcnt(5)
    ds_write_b128 v7, v[136:139] offset:35584
    s_waitcnt vmcnt(4)
    ds_write_b128 v7, v[140:143] offset:36608
    s_waitcnt vmcnt(3)
    ds_write_b128 v7, v[144:147] offset:37632
    s_waitcnt vmcnt(2)
    ds_write_b128 v7, v[148:151] offset:38656
    s_waitcnt vmcnt(1)
    ds_write_b128 v7, v[152:155] offset:39680
    s_waitcnt vmcnt(0)
    ds_write_b128 v7, v[156:159] offset:40704
    ds_read_b64_tr_b16 v[32:33], v20 offset:25344
    ds_read_b64_tr_b16 v[34:35], v20 offset:27392
    ds_read_b64_tr_b16 v[36:37], v21 offset:25344
    ds_read_b64_tr_b16 v[38:39], v21 offset:27392
    ds_read_b64_tr_b16 v[40:41], v22 offset:25344
    ds_read_b64_tr_b16 v[42:43], v22 offset:27392
    ds_read_b64_tr_b16 v[44:45], v23 offset:25344
    ds_read_b64_tr_b16 v[46:47], v23 offset:27392
    ds_read_b64_tr_b16 v[48:49], v20 offset:29440
    ds_read_b64_tr_b16 v[50:51], v20 offset:31488
    ds_read_b64_tr_b16 v[52:53], v21 offset:29440
    ds_read_b64_tr_b16 v[54:55], v21 offset:31488
    ds_read_b64_tr_b16 v[56:57], v22 offset:29440
    ds_read_b64_tr_b16 v[58:59], v22 offset:31488
    ds_read_b64_tr_b16 v[60:61], v23 offset:29440
    ds_read_b64_tr_b16 v[62:63], v23 offset:31488
    ds_read_b64_tr_b16 v[64:65], v20 offset:33536
    ds_read_b64_tr_b16 v[66:67], v20 offset:35584
    ds_read_b64_tr_b16 v[68:69], v21 offset:33536
    ds_read_b64_tr_b16 v[70:71], v21 offset:35584
    ds_read_b64_tr_b16 v[72:73], v22 offset:33536
    ds_read_b64_tr_b16 v[74:75], v22 offset:35584
    ds_read_b64_tr_b16 v[76:77], v23 offset:33536
    ds_read_b64_tr_b16 v[78:79], v23 offset:35584
    ds_read_b64_tr_b16 v[80:81], v20 offset:37632
    ds_read_b64_tr_b16 v[82:83], v20 offset:39680
    ds_read_b64_tr_b16 v[84:85], v21 offset:37632
    ds_read_b64_tr_b16 v[86:87], v21 offset:39680
    ds_read_b64_tr_b16 v[88:89], v22 offset:37632
    ds_read_b64_tr_b16 v[90:91], v22 offset:39680
    ds_read_b64_tr_b16 v[92:93], v23 offset:37632
    ds_read_b64_tr_b16 v[94:95], v23 offset:39680
    s_mov_b32 s11, 0
L_l1_1:
    ds_read_b32 v24, v4 offset:16408
    s_waitcnt lgkmcnt(0)
    v_cmp_ne_u32 vcc, s9, v24
    s_cbranch_vccz L_l1_1_ok
    s_sleep 1
    s_add_u32 s11, s11, 1
    s_cmp_lt_u32 s11, 2097152
    s_cbranch_scc1 L_l1_1
L_l1_1_ok:
    ds_read_b128 v[144:147], v5 offset:0
    ds_read_b128 v[148:151], v5 offset:64
    ds_read_b128 v[152:155], v5 offset:128
    ds_read_b128 v[156:159], v5 offset:192
    v_mov_b32 v27, s9
    v_mov_b32 v31, s9
    s_waitcnt lgkmcnt(0)
    v_mfma_f32_16x16x32_bf16 v[96:99], v[144:147], v[32:35], 0
    v_mfma_f32_16x16x32_bf16 v[100:103], v[144:147], v[36:39], 0
    v_mfma_f32_16x16x32_bf16 v[104:107], v[144:147], v[40:43], 0
    v_mfma_f32_16x16x32_bf16 v[108:111], v[144:147], v[44:47], 0
    v_mfma_f32_16x16x32_bf16 v[96:99], v[148:151], v[48:51], v[96:99]
    v_mfma_f32_16x16x32_bf16 v[100:103], v[148:151], v[52:55], v[100:103]
    v_mfma_f32_16x16x32_bf16 v[104:107], v[148:151], v[56:59], v[104:107]
    v_mfma_f32_16x16x32_bf16 v[108:111], v[148:151], v[60:63], v[108:111]
    v_mfma_f32_16x16x32_bf16 v[96:99], v[152:155], v[64:67], v[96:99]
    v_mfma_f32_16x16x32_bf16 v[100:103], v[152:155], v[68:71], v[100:103]
    v_mfma_f32_16x16x32_bf16 v[104:107], v[152:155], v[72:75], v[104:107]
    v_mfma_f32_16x16x32_bf16 v[108:111], v[152:155], v[76:79], v[108:111]
    v_mfma_f32_16x16x32_bf16 v[96:99], v[156:159], v[80:83], v[96:99]
    v_mfma_f32_16x16x32_bf16 v[100:103], v[156:159], v[84:87], v[100:103]
    v_mfma_f32_16x16x32_bf16 v[104:107], v[156:159], v[88:91], v[104:107]
    v_mfma_f32_16x16x32_bf16 v[108:111], v[156:159], v[92:95], v[108:111]
    s_nop 5
    v_cndmask_b32 v96, v96, v100, s[18:19]
    v_cndmask_b32 v97, v97, v101, s[18:19]
    v_cndmask_b32 v98, v98, v102, s[18:19]
    v_cndmask_b32 v99, v99, v103, s[18:19]
    v_cndmask_b32 v96, v96, v104, s[20:21]
    v_cndmask_b32 v97, v97, v105, s[20:21]
    v_cndmask_b32 v98, v98, v106, s[20:21]
    v_cndmask_b32 v99, v99, v107, s[20:21]
    v_cndmask_b32 v96, v96, v108, s[22:23]
    v_cndmask_b32 v97, v97, v109, s[22:23]
    v_cndmask_b32 v98, v98, v110, s[22:23]
    v_cndmask_b32 v99, v99, v111, s[22:23]
    ds_write_b32 v6, v96 offset:8192
    ds_write_b32 v6, v97 offset:8464
    ds_write_b32 v6, v98 offset:8736
    ds_write_b32 v6, v99 offset:9008
    ds_read_b32 v24, v17 offset:8192
    ds_read_b32 v25, v17 offset:8196
    ds_read_b32 v26, v17 offset:8200
    ds_read_b32 v28, v17 offset:8736
    ds_read_b32 v29, v17 offset:8740
    ds_read_b32 v30, v17 offset:8744
    s_mov_b32 s18, -1
    s_movk_i32 s19, 0xfff
    v_add_u32 v19, 0x800000, v18
    s_mov_b64 exec, s[18:19]
    s_waitcnt lgkmcnt(0)
    global_store_dwordx4 v18, v[24:27], s[60:61]
    global_store_dwordx4 v18, v[28:31], s[60:61] offset:768
    global_store_dwordx4 v19, v[24:27], s[60:61] sc1
    global_store_dwordx4 v19, v[28:31], s[60:61] offset:768 sc1
    s_mov_b64 exec, -1
    ds_write_b32 v4, v27 offset:16416
    s_branch L_CF
L_C1:
    s_and_b32 s24, s12, 3
    s_lshr_b32 s25, s12, 2
    s_lshl_b32 s25, s25, 7
    s_mov_b32 s26, s12
    v_lshrrev_b32 v5, 3, v0
    v_and_b32 v6, 7, v0
    s_lshl_b32 s10, s24, 7
    v_add_u32 v14, s10, v5
    v_mul_u32_u24 v14, 3584, v14
    v_lshl_add_u32 v14, v6, 4, v14
    v_add_u32 v14, s25, v14
    s_waitcnt lgkmcnt(0)
    s_load_dword s9, s[60:61], 49152
    global_load_dwordx4 v[96:99], v14, s[48:49] nt
    v_add_u32 v14, 0x7000, v14
    global_load_dwordx4 v[100:103], v14, s[48:49] nt
    v_add_u32 v14, 0x7000, v14
    global_load_dwordx4 v[104:107], v14, s[48:49] nt
    v_add_u32 v14, 0x7000, v14
    global_load_dwordx4 v[108:111], v14, s[48:49] nt
    v_add_u32 v14, 0x7000, v14
    global_load_dwordx4 v[112:115], v14, s[48:49] nt
    v_add_u32 v14, 0x7000, v14
    global_load_dwordx4 v[116:119], v14, s[48:49] nt
    v_add_u32 v14, 0x7000, v14
    global_load_dwordx4 v[120:123], v14, s[48:49] nt
    v_add_u32 v14, 0x7000, v14
    global_load_dwordx4 v[124:127], v14, s[48:49] nt
    v_add_u32 v14, 0x7000, v14
    global_load_dwordx4 v[128:131], v14, s[48:49] nt
    v_add_u32 v14, 0x7000, v14
    global_load_dwordx4 v[132:135], v14, s[48:49] nt
    v_add_u32 v14, 0x7000, v14
    global_load_dwordx4 v[136:139], v14, s[48:49] nt
    v_add_u32 v14, 0x7000, v14
    global_load_dwordx4 v[140:143], v14, s[48:49] nt
    v_add_u32 v14, 0x7000, v14
    global_load_dwordx4 v[144:147], v14, s[48:49] nt
    v_add_u32 v14, 0x7000, v14
    global_load_dwordx4 v[148:151], v14, s[48:49] nt
    v_add_u32 v14, 0x7000, v14
    global_load_dwordx4 v[152:155], v14, s[48:49] nt
    v_add_u32 v14, 0x7000, v14
    global_load_dwordx4 v[156:159], v14, s[48:49] nt
    v_bfe_u32 v7, v5, 1, 2
    v_lshlrev_b32 v7, 1, v7
    v_xor_b32 v7, v7, v6
    v_lshlrev_b32 v7, 4, v7
    v_lshl_add_u32 v7, v5, 7, v7
    v_lshrrev_b32 v5, 2, v0
    v_bfe_u32 v6, v0, 1, 1
    v_bfe_u32 v14, v5, 1, 2
    v_lshlrev_b32 v14, 1, v14
    v_or_b32 v6, v6, v14
    v_lshlrev_b32 v6, 4, v6
    v_and_b32 v14, 1, v0
    v_lshl_add_u32 v6, v14, 3, v6
    v_lshl_add_u32 v20, v5, 7, v6
    v_xor_b32 v21, 32, v20
    v_xor_b32 v22, 64, v20
    v_xor_b32 v23, 0x60, v20
    v_and_b32 v5, 3, v0
    v_lshlrev_b32 v5, 10, v5
    v_lshrrev_b32 v14, 4, v0
    v_lshl_add_u32 v5, v14, 4, v5
    s_lshl_b32 s10, s24, 8
    v_add_u32 v5, s10, v5
    v_cmp_eq_u32 s[18:19], 1, v14
    v_cmp_eq_u32 s[20:21], 2, v14
    v_cmp_eq_u32 s[22:23], 3, v14
    v_lshlrev_b32 v6, 2, v0
    v_cmp_le_u32 vcc, 22, v0
    s_nop 1
    v_cndmask_b32 v15, 0, 1, vcc
    v_mul_u32_u24 v16, 22, v15
    v_sub_u32 v16, v0, v16
    v_min_u32 v16, 21, v16
    v_mul_u32_u24 v17, 272, v15
    v_mul_u32_u24 v18, 12, v16
    v_add_u32 v17, v17, v18
    s_mul_i32 s10, s26, 1536
    s_add_u32 s10, s10, 786432
    v_mul_u32_u24 v18, 384, v15
    v_lshl_add_u32 v18, v16, 4, v18
    v_add_u32 v18, s10, v18
    s_waitcnt lgkmcnt(0)
    s_mul_i32 s9, s9, 0x915f77f5
    s_add_u32 s9, s9, 0x3c6ef35d
    s_or_b32 s9, s9, 1
    s_waitcnt vmcnt(15)
    ds_write_b128 v7, v[96:99] offset:41728
    s_waitcnt vmcnt(14)
    ds_write_b128 v7, v[100:103] offset:42752
    s_waitcnt vmcnt(13)
    ds_write_b128 v7, v[104:107] offset:43776
    s_waitcnt vmcnt(12)
    ds_write_b128 v7, v[108:111] offset:44800
    s_waitcnt vmcnt(11)
    ds_write_b128 v7, v[112:115] offset:45824
    s_waitcnt vmcnt(10)
    ds_write_b128 v7, v[116:119] offset:46848
    s_waitcnt vmcnt(9)
    ds_write_b128 v7, v[120:123] offset:47872
    s_waitcnt vmcnt(8)
    ds_write_b128 v7, v[124:127] offset:48896
    s_waitcnt vmcnt(7)
    ds_write_b128 v7, v[128:131] offset:49920
    s_waitcnt vmcnt(6)
    ds_write_b128 v7, v[132:135] offset:50944
    s_waitcnt vmcnt(5)
    ds_write_b128 v7, v[136:139] offset:51968
    s_waitcnt vmcnt(4)
    ds_write_b128 v7, v[140:143] offset:52992
    s_waitcnt vmcnt(3)
    ds_write_b128 v7, v[144:147] offset:54016
    s_waitcnt vmcnt(2)
    ds_write_b128 v7, v[148:151] offset:55040
    s_waitcnt vmcnt(1)
    ds_write_b128 v7, v[152:155] offset:56064
    s_waitcnt vmcnt(0)
    ds_write_b128 v7, v[156:159] offset:57088
    ds_read_b64_tr_b16 v[32:33], v20 offset:41728
    ds_read_b64_tr_b16 v[34:35], v20 offset:43776
    ds_read_b64_tr_b16 v[36:37], v21 offset:41728
    ds_read_b64_tr_b16 v[38:39], v21 offset:43776
    ds_read_b64_tr_b16 v[40:41], v22 offset:41728
    ds_read_b64_tr_b16 v[42:43], v22 offset:43776
    ds_read_b64_tr_b16 v[44:45], v23 offset:41728
    ds_read_b64_tr_b16 v[46:47], v23 offset:43776
    ds_read_b64_tr_b16 v[48:49], v20 offset:45824
    ds_read_b64_tr_b16 v[50:51], v20 offset:47872
    ds_read_b64_tr_b16 v[52:53], v21 offset:45824
    ds_read_b64_tr_b16 v[54:55], v21 offset:47872
    ds_read_b64_tr_b16 v[56:57], v22 offset:45824
    ds_read_b64_tr_b16 v[58:59], v22 offset:47872
    ds_read_b64_tr_b16 v[60:61], v23 offset:45824
    ds_read_b64_tr_b16 v[62:63], v23 offset:47872
    ds_read_b64_tr_b16 v[64:65], v20 offset:49920
    ds_read_b64_tr_b16 v[66:67], v20 offset:51968
    ds_read_b64_tr_b16 v[68:69], v21 offset:49920
    ds_read_b64_tr_b16 v[70:71], v21 offset:51968
    ds_read_b64_tr_b16 v[72:73], v22 offset:49920
    ds_read_b64_tr_b16 v[74:75], v22 offset:51968
    ds_read_b64_tr_b16 v[76:77], v23 offset:49920
    ds_read_b64_tr_b16 v[78:79], v23 offset:51968
    ds_read_b64_tr_b16 v[80:81], v20 offset:54016
    ds_read_b64_tr_b16 v[82:83], v20 offset:56064
    ds_read_b64_tr_b16 v[84:85], v21 offset:54016
    ds_read_b64_tr_b16 v[86:87], v21 offset:56064
    ds_read_b64_tr_b16 v[88:89], v22 offset:54016
    ds_read_b64_tr_b16 v[90:91], v22 offset:56064
    ds_read_b64_tr_b16 v[92:93], v23 offset:54016
    ds_read_b64_tr_b16 v[94:95], v23 offset:56064
    s_mov_b32 s11, 0
L_l1_2:
    ds_read_b32 v24, v4 offset:16412
    s_waitcnt lgkmcnt(0)
    v_cmp_ne_u32 vcc, s9, v24
    s_cbranch_vccz L_l1_2_ok
    s_sleep 1
    s_add_u32 s11, s11, 1
    s_cmp_lt_u32 s11, 2097152
    s_cbranch_scc1 L_l1_2
L_l1_2_ok:
    ds_read_b128 v[144:147], v5 offset:4096
    ds_read_b128 v[148:151], v5 offset:4160
    ds_read_b128 v[152:155], v5 offset:4224
    ds_read_b128 v[156:159], v5 offset:4288
    v_mov_b32 v27, s9
    v_mov_b32 v31, s9
    s_waitcnt lgkmcnt(0)
    v_mfma_f32_16x16x32_bf16 v[96:99], v[144:147], v[32:35], 0
    v_mfma_f32_16x16x32_bf16 v[100:103], v[144:147], v[36:39], 0
    v_mfma_f32_16x16x32_bf16 v[104:107], v[144:147], v[40:43], 0
    v_mfma_f32_16x16x32_bf16 v[108:111], v[144:147], v[44:47], 0
    v_mfma_f32_16x16x32_bf16 v[96:99], v[148:151], v[48:51], v[96:99]
    v_mfma_f32_16x16x32_bf16 v[100:103], v[148:151], v[52:55], v[100:103]
    v_mfma_f32_16x16x32_bf16 v[104:107], v[148:151], v[56:59], v[104:107]
    v_mfma_f32_16x16x32_bf16 v[108:111], v[148:151], v[60:63], v[108:111]
    v_mfma_f32_16x16x32_bf16 v[96:99], v[152:155], v[64:67], v[96:99]
    v_mfma_f32_16x16x32_bf16 v[100:103], v[152:155], v[68:71], v[100:103]
    v_mfma_f32_16x16x32_bf16 v[104:107], v[152:155], v[72:75], v[104:107]
    v_mfma_f32_16x16x32_bf16 v[108:111], v[152:155], v[76:79], v[108:111]
    v_mfma_f32_16x16x32_bf16 v[96:99], v[156:159], v[80:83], v[96:99]
    v_mfma_f32_16x16x32_bf16 v[100:103], v[156:159], v[84:87], v[100:103]
    v_mfma_f32_16x16x32_bf16 v[104:107], v[156:159], v[88:91], v[104:107]
    v_mfma_f32_16x16x32_bf16 v[108:111], v[156:159], v[92:95], v[108:111]
    s_nop 5
    v_cndmask_b32 v96, v96, v100, s[18:19]
    v_cndmask_b32 v97, v97, v101, s[18:19]
    v_cndmask_b32 v98, v98, v102, s[18:19]
    v_cndmask_b32 v99, v99, v103, s[18:19]
    v_cndmask_b32 v96, v96, v104, s[20:21]
    v_cndmask_b32 v97, v97, v105, s[20:21]
    v_cndmask_b32 v98, v98, v106, s[20:21]
    v_cndmask_b32 v99, v99, v107, s[20:21]
    v_cndmask_b32 v96, v96, v108, s[22:23]
    v_cndmask_b32 v97, v97, v109, s[22:23]
    v_cndmask_b32 v98, v98, v110, s[22:23]
    v_cndmask_b32 v99, v99, v111, s[22:23]
    ds_write_b32 v6, v96 offset:9280
    ds_write_b32 v6, v97 offset:9552
    ds_write_b32 v6, v98 offset:9824
    ds_write_b32 v6, v99 offset:10096
    ds_read_b32 v24, v17 offset:9280
    ds_read_b32 v25, v17 offset:9284
    ds_read_b32 v26, v17 offset:9288
    ds_read_b32 v28, v17 offset:9824
    ds_read_b32 v29, v17 offset:9828
    ds_read_b32 v30, v17 offset:9832
    s_mov_b32 s18, -1
    s_movk_i32 s19, 0xfff
    v_add_u32 v19, 0x800000, v18
    s_mov_b64 exec, s[18:19]
    s_waitcnt lgkmcnt(0)
    global_store_dwordx4 v18, v[24:27], s[60:61]
    global_store_dwordx4 v18, v[28:31], s[60:61] offset:768
    global_store_dwordx4 v19, v[24:27], s[60:61] sc1
    global_store_dwordx4 v19, v[28:31], s[60:61] offset:768 sc1
    s_mov_b64 exec, -1
L_CF:
    s_setprio 2
    v_cmp_le_u32 vcc, 22, v0
    s_nop 1
    v_cndmask_b32 v15, 0, 1, vcc
    v_mul_u32_u24 v16, 22, v15
    v_sub_u32 v16, v0, v16
    v_min_u32 v16, 21, v16
    s_lshl_b32 s10, s4, 3
    s_lshl_b32 s14, s6, 1
    s_add_u32 s10, s10, s14
    s_mul_i32 s10, s10, 6144
    s_mul_i32 s14, s7, 384
    s_add_u32 s10, s10, s14
    s_add_u32 s10, s10, 262144
    v_mul_u32_u24 v18, 6144, v15
    v_lshl_add_u32 v18, v16, 4, v18
    v_add_u32 v18, s10, v18
    s_mul_i32 s10, s6, 288
    v_mul_u32_u24 v17, 144, v15
    v_mul_u32_u24 v14, 6, v16
    v_add3_u32 v17, v17, v14, s10
    s_lshl_b32 s10, s6, 2
    v_mov_b32 v5, s10
    v_mov_b32 v6, s9
    s_mov_b32 s11, 0
L_l1_3:
    ds_read_b32 v24, v4 offset:16416
    s_waitcnt lgkmcnt(0)
    v_cmp_ne_u32 vcc, s9, v24
    s_cbranch_vccz L_l1_3_ok
    s_sleep 4
    s_add_u32 s11, s11, 1
    s_cmp_lt_u32 s11, 2097152
    s_cbranch_scc1 L_l1_3
L_l1_3_ok:
    s_sleep 2
    v_add_u32 v19, 3072, v18
    s_mov_b32 s18, -1
    s_movk_i32 s19, 0xfff
    s_mov_b64 exec, s[18:19]
    s_mov_b32 s20, 0
L_qf:
    global_load_dwordx4 v[32:35], v18, s[60:61] sc1
    global_load_dwordx4 v[36:39], v18, s[60:61] offset:1536 sc1
    global_load_dwordx4 v[40:43], v19, s[60:61] sc1
    global_load_dwordx4 v[44:47], v19, s[60:61] offset:1536 sc1
    s_waitcnt vmcnt(0)
    v_xor_b32 v48, s9, v35
    v_xor_b32 v49, s9, v39
    v_xor_b32 v50, s9, v43
    v_xor_b32 v51, s9, v47
    v_or3_b32 v48, v48, v49, v50
    v_or_b32 v48, v48, v51
    v_cmp_ne_u32 vcc, 0, v48
    s_nop 1
    s_and_b64 exec, exec, vcc
    s_cbranch_execz L_qf_ok
    s_sleep 2
    s_add_u32 s20, s20, 1
    s_cmp_eq_u32 s20, 8
    s_cselect_b32 s21, 0x800000, 0
    v_add_u32 v18, s21, v18
    v_add_u32 v19, s21, v19
    s_cmp_lt_u32 s20, 65536
    s_cbranch_scc1 L_qf
L_qf_ok:
    s_mov_b64 exec, s[18:19]
    v_pk_add_f32 v[32:33], v[32:33], v[36:37]
    v_pk_add_f32 v[40:41], v[40:41], v[44:45]
    v_add_f32 v34, v34, v38
    v_add_f32 v42, v42, v46
    v_pk_add_f32 v[32:33], v[32:33], v[40:41]
    v_add_f32 v34, v34, v42
    v_cvt_pk_bf16_f32 v32, v32, v33
    v_cvt_pk_bf16_f32 v34, v34, v34
    ds_write_b16 v17, v32 offset:10368
    ds_write_b16_d16_hi v17, v32 offset:10370
    ds_write_b16 v17, v34 offset:10372
    s_mov_b64 exec, -1
    ds_write_b32 v5, v6 offset:16320
    s_cmp_eq_u32 s6, 1
    s_cbranch_scc1 L_C_exit
    s_cmp_eq_u32 s6, 0
    s_cbranch_scc1 L_C_exit
    s_sub_u32 s14, 31, s5
    s_cmp_lt_u32 s14, s15
    s_cbranch_scc0 L_FIN
    s_add_u32 s14, s14, s16
    s_lshr_b32 s14, s14, 2
    s_sub_u32 s17, s6, 2
    s_mul_i32 s10, s14, 6144
    s_mul_i32 s15, s17, 768
    s_add_u32 s10, s10, s15
    s_add_u32 s10, s10, 786432
    v_mul_u32_u24 v18, 384, v15
    v_lshl_add_u32 v18, v16, 4, v18
    v_add_u32 v18, s10, v18
    s_mul_i32 s10, s17, 288
    v_mul_u32_u24 v17, 144, v15
    v_add3_u32 v17, v17, v14, s10
    s_lshl_b32 s14, s14, 7
    v_add_u32 v20, s14, v14
    v_min_u32 v21, 3580, v20
    v_add_u32 v21, 2, v21
    v_min_u32 v22, 3578, v20
    v_add_u32 v22, 4, v22
    global_load_ushort v52, v20, s[50:51]
    global_load_ushort v53, v21, s[50:51]
    global_load_ushort v54, v22, s[50:51]
    v_add_u32 v19, 3072, v18
    s_mov_b32 s18, -1
    s_movk_i32 s19, 0xfff
    s_mov_b64 exec, s[18:19]
    s_mov_b32 s20, 0
L_hf:
    global_load_dwordx4 v[32:35], v18, s[60:61] sc1
    global_load_dwordx4 v[36:39], v18, s[60:61] offset:1536 sc1
    global_load_dwordx4 v[40:43], v19, s[60:61] sc1
    global_load_dwordx4 v[44:47], v19, s[60:61] offset:1536 sc1
    s_waitcnt vmcnt(0)
    v_xor_b32 v48, s9, v35
    v_xor_b32 v49, s9, v39
    v_xor_b32 v50, s9, v43
    v_xor_b32 v51, s9, v47
    v_or3_b32 v48, v48, v49, v50
    v_or_b32 v48, v48, v51
    v_cmp_ne_u32 vcc, 0, v48
    s_nop 1
    s_and_b64 exec, exec, vcc
    s_cbranch_execz L_hf_ok
    s_sleep 4
    s_add_u32 s20, s20, 1
    s_cmp_eq_u32 s20, 8
    s_cselect_b32 s21, 0x800000, 0
    v_add_u32 v18, s21, v18
    v_add_u32 v19, s21, v19
    s_cmp_lt_u32 s20, 65536
    s_cbranch_scc1 L_hf
L_hf_ok:
    s_mov_b64 exec, s[18:19]
    v_pk_add_f32 v[32:33], v[32:33], v[36:37]
    v_pk_add_f32 v[40:41], v[40:41], v[44:45]
    v_add_f32 v34, v34, v38
    v_add_f32 v42, v42, v46
    v_pk_add_f32 v[32:33], v[32:33], v[40:41]
    v_add_f32 v34, v34, v42
    v_cvt_pk_bf16_f32 v32, v32, v32
    v_and_b32 v32, 0xffff0000, v32
    v_cvt_pk_bf16_f32 v33, v33, v33
    v_and_b32 v33, 0xffff0000, v33
    v_cvt_pk_bf16_f32 v34, v34, v34
    v_and_b32 v34, 0xffff0000, v34
    v_lshlrev_b32 v52, 16, v52
    v_lshlrev_b32 v53, 16, v53
    v_lshlrev_b32 v54, 16, v54
    v_add_f32 v32, v32, v52
    v_add_f32 v33, v33, v53
    v_add_f32 v34, v34, v54
    v_cvt_pk_bf16_f32 v32, v32, v32
    v_and_b32 v32, 0xffff0000, v32
    v_cvt_pk_bf16_f32 v33, v33, v33
    v_and_b32 v33, 0xffff0000, v33
    v_cvt_pk_bf16_f32 v34, v34, v34
    v_and_b32 v34, 0xffff0000, v34
    s_mov_b32 s14, 0xbdd2d3e8
    v_mov_b32 v28, 0xc0135761
    v_mul_f32 v24, v32, v32
    v_mul_f32 v25, v33, v33
    v_mul_f32 v26, v34, v34
    v_fma_f32 v24, v24, s14, v28
    v_fma_f32 v25, v25, s14, v28
    v_fma_f32 v26, v26, s14, v28
    v_mul_f32 v24, v24, v32
    v_mul_f32 v25, v25, v33
    v_mul_f32 v26, v26, v34
    v_exp_f32 v24, v24
    v_exp_f32 v25, v25
    v_exp_f32 v26, v26
    v_add_f32 v24, 1.0, v24
    v_add_f32 v25, 1.0, v25
    v_add_f32 v26, 1.0, v26
    v_rcp_f32 v24, v24
    v_rcp_f32 v25, v25
    v_rcp_f32 v26, v26
    v_mul_f32 v32, v32, v24
    v_mul_f32 v33, v33, v25
    v_mul_f32 v34, v34, v26
    v_cvt_pk_bf16_f32 v32, v32, v33
    v_cvt_pk_bf16_f32 v34, v34, v34
    ds_write_b16 v17, v32 offset:15744
    ds_write_b16_d16_hi v17, v32 offset:15746
    ds_write_b16 v17, v34 offset:15748
    s_mov_b64 exec, -1
    ds_write_b32 v5, v6 offset:16392
    s_branch L_FIN
L_C_exit:
    s_endpgm
L_FIN:
    s_and_b32 s64, s9, 0xff
    s_bfe_u32 s65, s9, 0x80008
    s_bfe_u32 s66, s9, 0x80010
    s_lshr_b32 s67, s9, 24
    s_mov_b32 s68, 0xffffff00
    s_mov_b32 s69, 0x0c0c0400
    s_mov_b32 s70, 0x04000c0c
    v_mov_b32 v154, s68
    s_and_b32 s14, s5, 3
    s_lshr_b32 s15, s5, 2
    v_lshrrev_b32 v1, 4, v0
    v_and_b32 v2, 15, v0
    s_lshl_b32 s10, s4, 16
    s_lshl_b32 s16, s15, 8
    s_add_u32 s10, s10, s16
    v_lshlrev_b32 v20, 4, v2
    v_add_u32 v20, s10, v20
    v_lshlrev_b32 v21, 2, v1
    v_add_u32 v21, s14, v21
    v_sub_u32 v22, 31, v21
    s_cmp_eq_u32 s6, 3
    s_cselect_b64 vcc, -1, 0
    v_cndmask_b32 v21, v22, v21, vcc
    s_cselect_b32 s16, 0x200000, 0
    s_cselect_b32 s17, 0, 0x280000
    s_add_u32 s16, s16, s17
    v_lshl_add_u32 v21, v21, 11, v20
    v_add_u32 v21, s16, v21
    v_add_u32 v22, 0x8000, v21
    s_cmp_eq_u32 s6, 3
    s_cselect_b32 s16, 0x300000, 0
    s_cselect_b32 s17, 0, 0x320000
    s_add_u32 s16, s16, s17
    s_lshl_b32 s10, s5, 11
    s_add_u32 s16, s16, s10
    s_lshl_b32 s17, s4, 8
    s_add_u32 s17, s17, s16
    v_lshlrev_b32 v25, 4, v2
    v_add_u32 v25, s17, v25
    s_sub_u32 s24, s4, s5
    s_and_b32 s24, s24, 7
    s_lshr_b32 s25, s24, 2
    s_and_b32 s24, s24, 3
    s_lshl_b32 s26, s25, 7
    s_add_u32 s16, s16, s26
    v_lshrrev_b32 v3, 3, v0
    v_and_b32 v23, 7, v0
    v_lshlrev_b32 v24, 8, v3
    v_lshl_add_u32 v24, v23, 4, v24
    v_add_u32 v24, s16, v24
    s_lshl_b32 s10, s15, 4
    s_lshl_b32 s26, s25, 3
    s_add_u32 s10, s10, s26
    v_add_u32 v27, s10, v23
    v_and_b32 v28, 1, v27
    v_lshlrev_b32 v28, 2, v28
    v_lshl_add_u32 v28, v1, 3, v28
    v_bfe_u32 v29, v27, 1, 2
    v_add_u32 v28, v28, v29
    v_bfe_u32 v29, v27, 3, 2
    v_lshl_add_u32 v28, v29, 5, v28
    s_lshl_b32 s10, s14, 7
    v_add_u32 v28, s10, v28
    v_lshlrev_b32 v28, 1, v28
    v_lshrrev_b32 v29, 5, v27
    v_lshl_add_u32 v29, v29, 10, v28
    global_load_ushort v30, v29, s[36:37]
    global_load_ushort v31, v28, s[54:55]
    v_lshlrev_b32 v26, 2, v0
    s_sub_u32 s10, s6, 2
    s_lshl_b32 s10, s10, 4
    v_mov_b32 v19, s10
    s_mov_b32 s11, 0
L_ls_4:
    ds_read_b128 v[32:35], v19 offset:16624
    s_waitcnt lgkmcnt(0)
    v_xor_b32 v32, s9, v32
    v_xor_b32 v33, s9, v33
    v_xor_b32 v34, s9, v34
    v_xor_b32 v35, s9, v35
    v_or3_b32 v32, v32, v33, v34
    v_or_b32 v32, v32, v35
    v_cmp_ne_u32 vcc, 0, v32
    s_cbranch_vccz L_ls_4_ok
    s_sleep 4
    s_add_u32 s11, s11, 1
    s_cmp_lt_u32 s11, 2097152
    s_cbranch_scc1 L_ls_4
L_ls_4_ok:
    v_mov_b32 v32, 0
    v_mov_b32 v33, 0
    v_mov_b32 v34, 0
    v_mov_b32 v35, 0
    v_mov_b32 v36, 0
    v_mov_b32 v37, 0
    v_mov_b32 v38, 0
    v_mov_b32 v39, 0
    ds_write_b128 v19, v[32:35] offset:16624
    global_load_dwordx4 v[40:43], v21, s[60:61] sc1
    global_load_dwordx4 v[44:47], v22, s[60:61] sc1
    v_lshrrev_b32 v18, 2, v19
    s_mov_b32 s11, 0
L_l1_5:
    ds_read_b32 v48, v18 offset:16660
    s_waitcnt lgkmcnt(0)
    v_cmp_ne_u32 vcc, s9, v48
    s_cbranch_vccz L_l1_5_ok
    s_sleep 2
    s_add_u32 s11, s11, 1
    s_cmp_lt_u32 s11, 2097152
    s_cbranch_scc1 L_l1_5
L_l1_5_ok:
    ds_write_b32 v18, v4 offset:16660
    s_cmp_eq_u32 s6, 3
    s_cbranch_scc1 L_F_s
    s_cmp_eq_u32 s4, 5
    s_cbranch_scc1 L_F_l2
    s_mov_b32 s20, 0
L_F_m:
    global_load_dwordx4 v[32:35], v21, s[60:61] sc1
    s_waitcnt vmcnt(0)
    v_perm_b32 v48, v33, v32, s69
    v_perm_b32 v49, v35, v34, s70
    v_or_b32 v48, v48, v49
    v_xor_b32 v48, s9, v48
    v_cmp_ne_u32 vcc, 0, v48
    s_nop 1
    s_and_b64 exec, exec, vcc
    s_cbranch_execz L_F_l1ok
    s_add_u32 s20, s20, 1
    s_cmp_eq_u32 s20, 64
    s_cselect_b32 s21, 0x800000, 0
    v_add_u32 v21, s21, v21
    s_cmp_lt_u32 s20, 65536
    s_cbranch_scc1 L_F_m
    s_branch L_F_l1ok
L_F_s:
    s_mov_b32 s20, 0
L_F_s1:
    global_load_dwordx4 v[32:35], v21, s[60:61] sc1
    global_load_dwordx4 v[36:39], v22, s[60:61] sc1
    s_waitcnt vmcnt(0)
    v_perm_b32 v48, v33, v32, s69
    v_perm_b32 v49, v35, v34, s70
    v_or_b32 v48, v48, v49
    v_xor_b32 v48, s9, v48
    v_perm_b32 v50, v37, v36, s69
    v_perm_b32 v49, v39, v38, s70
    v_or_b32 v50, v50, v49
    v_xor_b32 v50, s9, v50
    v_or_b32 v48, v48, v50
    v_cmp_ne_u32 vcc, 0, v48
    s_nop 1
    s_and_b64 exec, exec, vcc
    s_cbranch_execz L_F_l1ok
    s_add_u32 s20, s20, 1
    s_cmp_eq_u32 s20, 64
    s_cselect_b32 s21, 0x800000, 0
    v_add_u32 v21, s21, v21
    v_add_u32 v22, s21, v22
    s_cmp_lt_u32 s20, 65536
    s_cbranch_scc1 L_F_s1
L_F_l1ok:
    s_mov_b64 exec, -1
    v_and_b32 v32, s68, v32
    v_and_b32 v33, s68, v33
    v_and_b32 v34, s68, v34
    v_and_b32 v35, s68, v35
    v_and_b32 v36, s68, v36
    v_and_b32 v37, s68, v37
    v_and_b32 v38, s68, v38
    v_and_b32 v39, s68, v39
    v_pk_add_f32 v[32:33], v[32:33], v[36:37]
    v_pk_add_f32 v[34:35], v[34:35], v[38:39]
    v_mov_b32 v36, v32
    v_mov_b32 v37, v33
    v_mov_b32 v38, v34
    v_mov_b32 v39, v35
    v_permlane32_swap_b32 v32, v36
    v_permlane32_swap_b32 v33, v37
    v_permlane32_swap_b32 v34, v38
    v_permlane32_swap_b32 v35, v39
    v_add_f32 v32, v32, v36
    v_add_f32 v33, v33, v37
    v_add_f32 v34, v34, v38
    v_add_f32 v35, v35, v39
    v_mov_b32 v36, v32
    v_mov_b32 v37, v33
    v_mov_b32 v38, v34
    v_mov_b32 v39, v35
    v_permlane16_swap_b32 v32, v36
    v_permlane16_swap_b32 v33, v37
    v_permlane16_swap_b32 v34, v38
    v_permlane16_swap_b32 v35, v39
    v_add_f32 v32, v32, v36
    v_add_f32 v33, v33, v37
    v_add_f32 v34, v34, v38
    v_add_f32 v35, v35, v39
    v_and_or_b32 v32, v32, v154, s64
    v_and_or_b32 v33, v33, v154, s65
    v_and_or_b32 v34, v34, v154, s66
    v_and_or_b32 v35, v35, v154, s67
    s_mov_b64 exec, 0xffff
    global_store_dwordx4 v25, v[32:35], s[60:61] sc1
    s_mov_b64 exec, -1
L_F_l2:
    s_cmp_eq_u32 s24, 0
    s_cbranch_scc0 L_C_exit
    v_mov_b32 v40, 0
    v_mov_b32 v41, 0
    v_mov_b32 v42, 0
    v_mov_b32 v43, 0
    s_cmp_eq_u32 s6, 3
    s_cselect_b32 s21, -1, 0xffff00ff
    s_cselect_b32 s22, -1, 0xffffffff
    s_mov_b32 exec_hi, s21
    s_mov_b32 exec_lo, s22
    s_mov_b32 s20, 0
L_F_2:
    global_load_dwordx4 v[40:43], v24, s[60:61] sc1
    s_waitcnt vmcnt(0)
    v_perm_b32 v48, v41, v40, s69
    v_perm_b32 v49, v43, v42, s70
    v_or_b32 v48, v48, v49
    v_xor_b32 v48, s9, v48
    v_cmp_ne_u32 vcc, 0, v48
    s_nop 1
    s_and_b64 exec, exec, vcc
    s_cbranch_execz L_F_2ok
    s_add_u32 s20, s20, 1
    s_cmp_lt_u32 s20, 65536
    s_cbranch_scc1 L_F_2
L_F_2ok:
    s_mov_b64 exec, -1
    v_and_b32 v40, s68, v40
    v_and_b32 v41, s68, v41
    v_and_b32 v42, s68, v42
    v_and_b32 v43, s68, v43
    s_nop 0
    v_permlane32_swap_b32 v40, v42
    v_permlane32_swap_b32 v41, v43
    v_add_f32 v40, v40, v42
    v_add_f32 v41, v41, v43
    s_nop 1
    v_permlane16_swap_b32 v40, v41
    v_add_f32 v40, v40, v41
    s_nop 1
    v_add_f32_dpp v40, v40, v40 row_ror:8 row_mask:0xf bank_mask:0xf
    v_cvt_pk_bf16_f32 v40, v40, v40
    v_and_b32 v40, 0xffff0000, v40
    s_cmp_eq_u32 s6, 3
    s_cbranch_scc1 L_F_out
    v_lshlrev_b32 v31, 16, v31
    v_add_f32 v40, v40, v31
    v_cvt_pk_bf16_f32 v40, v40, v40
    v_and_b32 v40, 0xffff0000, v40
    v_mul_f32 v41, 0xbfb8aa3b, v40
    v_exp_f32 v41, v41
    s_nop 0
    v_add_f32 v41, 1.0, v41
    v_rcp_f32 v41, v41
    s_nop 0
    v_mul_f32 v40, v40, v41
    v_cvt_pk_bf16_f32 v40, v40, v40
    v_and_b32 v40, 0xffff0000, v40
    ds_write_b32 v26, v40 offset:16704
    ds_write_b32 v4, v6 offset:16656
    s_branch L_C_exit
L_F_out:
    v_lshlrev_b32 v30, 16, v30
    s_mov_b32 s11, 0
L_l1_6:
    ds_read_b32 v41, v4 offset:16656
    s_waitcnt lgkmcnt(0)
    v_cmp_ne_u32 vcc, s9, v41
    s_cbranch_vccz L_l1_6_ok
    s_add_u32 s11, s11, 1
    s_cmp_lt_u32 s11, 2097152
    s_cbranch_scc1 L_l1_6
L_l1_6_ok:
    ds_read_b32 v41, v26 offset:16704
    ds_write_b32 v4, v4 offset:16656
    s_waitcnt lgkmcnt(0)
    v_mul_f32 v40, v40, v41
    v_cvt_pk_bf16_f32 v40, v40, v40
    v_and_b32 v40, 0xffff0000, v40
    v_add_f32 v40, v40, v30
    v_cvt_pk_bf16_f32 v40, v40, v40
    s_mov_b32 exec_lo, 0x00ff00ff
    s_mov_b32 exec_hi, 0x00ff00ff
    global_store_short v29, v40, s[56:57]
    s_cmp_eq_u32 s2, 0
    s_cbranch_scc0 L_noep
    s_mov_b64 exec, 1
    v_mov_b32 v41, s9
    v_mov_b32 v42, 0xc000
    global_store_dword v42, v41, s[60:61] sc1
L_noep:
    s_mov_b64 exec, -1
    s_branch L_C_exit
L_K:
    s_setprio 2
    s_lshl_b32 s10, s7, 24
    s_lshl_b32 s11, s4, 21
    s_add_u32 s10, s10, s11
    s_lshl_b32 s11, s8, 16
    s_add_u32 s10, s10, s11
    s_add_u32 s10, s10, 1572864
    s_mul_i32 s18, s5, 2
    s_lshl_b32 s11, s6, 4
    s_add_u32 s18, s18, s11
    v_lshrrev_b32 v1, 4, v0
    v_and_b32 v2, 3, v0
    v_bfe_u32 v3, v0, 2, 2
    v_mov_b32 v4, 0
    s_lshl_b32 s28, s6, 2
    v_mov_b32 v5, s28
    s_waitcnt lgkmcnt(0)
    s_mov_b64 s[12:13], s[44:45]
    s_mov_b64 s[14:15], s[52:53]
    s_mov_b64 s[16:17], s[56:57]
    s_mov_b64 s[20:21], s[60:61]
    s_add_u32 s22, s38, s10
    s_addc_u32 s23, s39, 0
    s_load_dword s9, s[20:21], 49152
    v_lshlrev_b32 v6, 8, v3
    v_lshl_add_u32 v6, v1, 6, v6
    v_lshl_add_u32 v6, v2, 4, v6
    s_add_u32 s10, s18, 0
    s_and_b32 s10, s10, 63
    s_lshl_b32 s10, s10, 10
    v_add_u32 v7, s10, v6
    global_load_dwordx4 v[80:83], v7, s[22:23] nt
    s_add_u32 s10, s18, 1
    s_and_b32 s10, s10, 63
    s_lshl_b32 s10, s10, 10
    v_add_u32 v7, s10, v6
    global_load_dwordx4 v[84:87], v7, s[22:23] nt
    s_add_u32 s10, s18, 2
    s_and_b32 s10, s10, 63
    s_lshl_b32 s10, s10, 10
    v_add_u32 v7, s10, v6
    global_load_dwordx4 v[88:91], v7, s[22:23] nt
    s_waitcnt lgkmcnt(0)
    s_mul_i32 s9, s9, 0x915f77f5
    s_add_u32 s9, s9, 0x3c6ef35d
    s_or_b32 s9, s9, 1
    s_waitcnt vmcnt(2)
    s_add_u32 s10, s18, 3
    s_and_b32 s10, s10, 63
    s_lshl_b32 s10, s10, 10
    v_add_u32 v7, s10, v6
    global_load_dwordx4 v[92:95], v7, s[22:23] nt
    s_waitcnt vmcnt(3)
    s_add_u32 s10, s18, 4
    s_and_b32 s10, s10, 63
    s_lshl_b32 s10, s10, 10
    v_add_u32 v7, s10, v6
    global_load_dwordx4 v[96:99], v7, s[22:23] nt
    s_waitcnt vmcnt(3)
    s_add_u32 s10, s18, 5
    s_and_b32 s10, s10, 63
    s_lshl_b32 s10, s10, 10
    v_add_u32 v7, s10, v6
    global_load_dwordx4 v[100:103], v7, s[22:23] nt
    s_waitcnt vmcnt(4)
    s_add_u32 s10, s18, 6
    s_and_b32 s10, s10, 63
    s_lshl_b32 s10, s10, 10
    v_add_u32 v7, s10, v6
    global_load_dwordx4 v[104:107], v7, s[22:23] nt
    s_waitcnt vmcnt(4)
    s_add_u32 s10, s18, 7
    s_and_b32 s10, s10, 63
    s_lshl_b32 s10, s10, 10
    v_add_u32 v7, s10, v6
    global_load_dwordx4 v[108:111], v7, s[22:23] nt
    s_waitcnt vmcnt(4)
    s_add_u32 s10, s18, 8
    s_and_b32 s10, s10, 63
    s_lshl_b32 s10, s10, 10
    v_add_u32 v7, s10, v6
    global_load_dwordx4 v[112:115], v7, s[22:23] nt
    s_waitcnt vmcnt(4)
    s_add_u32 s10, s18, 9
    s_and_b32 s10, s10, 63
    s_lshl_b32 s10, s10, 10
    v_add_u32 v7, s10, v6
    global_load_dwordx4 v[116:119], v7, s[22:23] nt
    s_waitcnt vmcnt(4)
    s_add_u32 s10, s18, 10
    s_and_b32 s10, s10, 63
    s_lshl_b32 s10, s10, 10
    v_add_u32 v7, s10, v6
    global_load_dwordx4 v[120:123], v7, s[22:23] nt
    s_waitcnt vmcnt(4)
    s_add_u32 s10, s18, 11
    s_and_b32 s10, s10, 63
    s_lshl_b32 s10, s10, 10
    v_add_u32 v7, s10, v6
    global_load_dwordx4 v[124:127], v7, s[22:23] nt
    s_waitcnt vmcnt(4)
    s_add_u32 s10, s18, 12
    s_and_b32 s10, s10, 63
    s_lshl_b32 s10, s10, 10
    v_add_u32 v7, s10, v6
    global_load_dwordx4 v[128:131], v7, s[22:23] nt
    s_waitcnt vmcnt(4)
    s_add_u32 s10, s18, 13
    s_and_b32 s10, s10, 63
    s_lshl_b32 s10, s10, 10
    v_add_u32 v7, s10, v6
    global_load_dwordx4 v[132:135], v7, s[22:23] nt
    s_waitcnt vmcnt(4)
    s_add_u32 s10, s18, 14
    s_and_b32 s10, s10, 63
    s_lshl_b32 s10, s10, 10
    v_add_u32 v7, s10, v6
    global_load_dwordx4 v[136:139], v7, s[22:23] nt
    s_waitcnt vmcnt(4)
    s_add_u32 s10, s18, 15
    s_and_b32 s10, s10, 63
    s_lshl_b32 s10, s10, 10
    v_add_u32 v7, s10, v6
    global_load_dwordx4 v[140:143], v7, s[22:23] nt
    s_lshl_b32 s26, s4, 2
    s_lshr_b32 s24, 0x44044444, s26
    s_and_b32 s24, s24, 15
    s_lshl_b32 s24, s24, 2
    s_mov_b32 s25, 0x18141410
    s_cmp_lt_u32 s4, 4
    s_cselect_b32 s25, 0xc080400, s25
    s_and_b32 s26, s4, 3
    s_lshl_b32 s26, s26, 3
    s_lshr_b32 s25, s25, s26
    s_and_b32 s25, s25, 0xff
    s_lshl_b32 s25, s25, 2
    s_sub_u32 s34, 31, s5
    s_cmp_lt_u32 s34, s24
    s_cselect_b32 s35, 1, 0
    s_add_u32 s34, s34, s25
    s_lshr_b32 s24, s34, 2
    s_lshl_b32 s24, s24, 6
    s_lshl_b32 s25, s6, 4
    s_add_u32 s24, s24, s25
    s_lshl_b32 s24, s24, 10
    s_and_b32 s25, s34, 3
    s_lshl_b32 s25, s25, 8
    s_add_u32 s24, s24, s25
    v_and_b32 v148, 15, v0
    v_lshlrev_b32 v148, 4, v148
    v_lshl_add_u32 v148, v1, 11, v148
    v_add_u32 v148, s24, v148
    v_add_u32 v149, 0x2000, v148
    v_and_b32 v10, 1, v0
    v_cmp_eq_u32 s[30:31], 1, v10
    v_and_b32 v10, 2, v0
    v_cmp_eq_u32 s[32:33], 2, v10
    v_mov_b32 v9, s9
    v_mul_u32_u24 v8, 288, v3
    v_lshl_add_u32 v8, v1, 6, v8
    v_lshl_add_u32 v8, v2, 4, v8
    v_lshrrev_b32 v10, 1, v1
    v_lshl_add_u32 v8, v10, 4, v8
    v_add_u32 v10, 2, v9
    s_waitcnt vmcnt(4)
    ds_write_b32 v5, v10 offset:16368
    v_add_u32 v10, 4, v9
    s_waitcnt vmcnt(3)
    ds_write_b32 v5, v10 offset:16368
    v_add_u32 v10, 6, v9
    s_waitcnt vmcnt(2)
    ds_write_b32 v5, v10 offset:16368
    v_add_u32 v10, 8, v9
    s_waitcnt vmcnt(1)
    ds_write_b32 v5, v10 offset:16368
    v_add_u32 v10, 10, v9
    s_waitcnt vmcnt(0)
    ds_write_b32 v5, v10 offset:16368
    s_mov_b32 s11, 0
L_ls_7:
    ds_read_b128 v[12:15], v4 offset:16320
    s_waitcnt lgkmcnt(0)
    v_xor_b32 v12, s9, v12
    v_xor_b32 v13, s9, v13
    v_xor_b32 v14, s9, v14
    v_xor_b32 v15, s9, v15
    v_or3_b32 v12, v12, v13, v14
    v_or_b32 v12, v12, v15
    v_cmp_ne_u32 vcc, 0, v12
    s_cbranch_vccz L_ls_7_ok
    s_sleep 1
    s_add_u32 s11, s11, 1
    s_cmp_lt_u32 s11, 2097152
    s_cbranch_scc1 L_ls_7
L_ls_7_ok:
    ds_read_b128 v[12:15], v8 offset:10368
    s_waitcnt lgkmcnt(0)
    v_mfma_f32_16x16x32_bf16 v[72:75], v[80:83], v[12:15], 0
    v_mfma_f32_16x16x32_bf16 v[80:83], v[84:87], v[12:15], 0
    v_mfma_f32_16x16x32_bf16 v[84:87], v[88:91], v[12:15], 0
    v_mfma_f32_16x16x32_bf16 v[88:91], v[92:95], v[12:15], 0
    v_mfma_f32_16x16x32_bf16 v[92:95], v[96:99], v[12:15], 0
    v_mfma_f32_16x16x32_bf16 v[96:99], v[100:103], v[12:15], 0
    v_mfma_f32_16x16x32_bf16 v[100:103], v[104:107], v[12:15], 0
    v_mfma_f32_16x16x32_bf16 v[104:107], v[108:111], v[12:15], 0
    v_mfma_f32_16x16x32_bf16 v[108:111], v[112:115], v[12:15], 0
    v_mfma_f32_16x16x32_bf16 v[112:115], v[116:119], v[12:15], 0
    v_mfma_f32_16x16x32_bf16 v[116:119], v[120:123], v[12:15], 0
    v_mfma_f32_16x16x32_bf16 v[120:123], v[124:127], v[12:15], 0
    v_mfma_f32_16x16x32_bf16 v[124:127], v[128:131], v[12:15], 0
    v_mfma_f32_16x16x32_bf16 v[128:131], v[132:135], v[12:15], 0
    v_mfma_f32_16x16x32_bf16 v[132:135], v[136:139], v[12:15], 0
    v_mfma_f32_16x16x32_bf16 v[136:139], v[140:143], v[12:15], 0
    v_mov_b32_dpp v24, v72 quad_perm:[0,0,0,0] row_mask:0xf bank_mask:0xf
    v_mov_b32_dpp v25, v80 quad_perm:[0,0,0,0] row_mask:0xf bank_mask:0xf
    v_mov_b32_dpp v26, v84 quad_perm:[0,0,0,0] row_mask:0xf bank_mask:0xf
    v_mov_b32_dpp v27, v88 quad_perm:[0,0,0,0] row_mask:0xf bank_mask:0xf
    v_mov_b32_dpp v28, v92 quad_perm:[0,0,0,0] row_mask:0xf bank_mask:0xf
    v_mov_b32_dpp v29, v96 quad_perm:[0,0,0,0] row_mask:0xf bank_mask:0xf
    v_mov_b32_dpp v30, v100 quad_perm:[0,0,0,0] row_mask:0xf bank_mask:0xf
    v_mov_b32_dpp v31, v104 quad_perm:[0,0,0,0] row_mask:0xf bank_mask:0xf
    v_mov_b32_dpp v32, v108 quad_perm:[0,0,0,0] row_mask:0xf bank_mask:0xf
    v_mov_b32_dpp v33, v112 quad_perm:[0,0,0,0] row_mask:0xf bank_mask:0xf
    v_mov_b32_dpp v34, v116 quad_perm:[0,0,0,0] row_mask:0xf bank_mask:0xf
    v_mov_b32_dpp v35, v120 quad_perm:[0,0,0,0] row_mask:0xf bank_mask:0xf
    v_mov_b32_dpp v36, v124 quad_perm:[0,0,0,0] row_mask:0xf bank_mask:0xf
    v_mov_b32_dpp v37, v128 quad_perm:[0,0,0,0] row_mask:0xf bank_mask:0xf
    v_mov_b32_dpp v38, v132 quad_perm:[0,0,0,0] row_mask:0xf bank_mask:0xf
    v_mov_b32_dpp v39, v136 quad_perm:[0,0,0,0] row_mask:0xf bank_mask:0xf
    v_add_f32_dpp v24, v73, v24 quad_perm:[1,1,1,1] row_mask:0xf bank_mask:0xf
    v_add_f32_dpp v25, v81, v25 quad_perm:[1,1,1,1] row_mask:0xf bank_mask:0xf
    v_add_f32_dpp v26, v85, v26 quad_perm:[1,1,1,1] row_mask:0xf bank_mask:0xf
    v_add_f32_dpp v27, v89, v27 quad_perm:[1,1,1,1] row_mask:0xf bank_mask:0xf
    v_add_f32_dpp v28, v93, v28 quad_perm:[1,1,1,1] row_mask:0xf bank_mask:0xf
    v_add_f32_dpp v29, v97, v29 quad_perm:[1,1,1,1] row_mask:0xf bank_mask:0xf
    v_add_f32_dpp v30, v101, v30 quad_perm:[1,1,1,1] row_mask:0xf bank_mask:0xf
    v_add_f32_dpp v31, v105, v31 quad_perm:[1,1,1,1] row_mask:0xf bank_mask:0xf
    v_add_f32_dpp v32, v109, v32 quad_perm:[1,1,1,1] row_mask:0xf bank_mask:0xf
    v_add_f32_dpp v33, v113, v33 quad_perm:[1,1,1,1] row_mask:0xf bank_mask:0xf
    v_add_f32_dpp v34, v117, v34 quad_perm:[1,1,1,1] row_mask:0xf bank_mask:0xf
    v_add_f32_dpp v35, v121, v35 quad_perm:[1,1,1,1] row_mask:0xf bank_mask:0xf
    v_add_f32_dpp v36, v125, v36 quad_perm:[1,1,1,1] row_mask:0xf bank_mask:0xf
    v_add_f32_dpp v37, v129, v37 quad_perm:[1,1,1,1] row_mask:0xf bank_mask:0xf
    v_add_f32_dpp v38, v133, v38 quad_perm:[1,1,1,1] row_mask:0xf bank_mask:0xf
    v_add_f32_dpp v39, v137, v39 quad_perm:[1,1,1,1] row_mask:0xf bank_mask:0xf
    v_add_f32_dpp v24, v74, v24 quad_perm:[2,2,2,2] row_mask:0xf bank_mask:0xf
    v_add_f32_dpp v25, v82, v25 quad_perm:[2,2,2,2] row_mask:0xf bank_mask:0xf
    v_add_f32_dpp v26, v86, v26 quad_perm:[2,2,2,2] row_mask:0xf bank_mask:0xf
    v_add_f32_dpp v27, v90, v27 quad_perm:[2,2,2,2] row_mask:0xf bank_mask:0xf
    v_add_f32_dpp v28, v94, v28 quad_perm:[2,2,2,2] row_mask:0xf bank_mask:0xf
    v_add_f32_dpp v29, v98, v29 quad_perm:[2,2,2,2] row_mask:0xf bank_mask:0xf
    v_add_f32_dpp v30, v102, v30 quad_perm:[2,2,2,2] row_mask:0xf bank_mask:0xf
    v_add_f32_dpp v31, v106, v31 quad_perm:[2,2,2,2] row_mask:0xf bank_mask:0xf
    v_add_f32_dpp v32, v110, v32 quad_perm:[2,2,2,2] row_mask:0xf bank_mask:0xf
    v_add_f32_dpp v33, v114, v33 quad_perm:[2,2,2,2] row_mask:0xf bank_mask:0xf
    v_add_f32_dpp v34, v118, v34 quad_perm:[2,2,2,2] row_mask:0xf bank_mask:0xf
    v_add_f32_dpp v35, v122, v35 quad_perm:[2,2,2,2] row_mask:0xf bank_mask:0xf
    v_add_f32_dpp v36, v126, v36 quad_perm:[2,2,2,2] row_mask:0xf bank_mask:0xf
    v_add_f32_dpp v37, v130, v37 quad_perm:[2,2,2,2] row_mask:0xf bank_mask:0xf
    v_add_f32_dpp v38, v134, v38 quad_perm:[2,2,2,2] row_mask:0xf bank_mask:0xf
    v_add_f32_dpp v39, v138, v39 quad_perm:[2,2,2,2] row_mask:0xf bank_mask:0xf
    v_add_f32_dpp v24, v75, v24 quad_perm:[3,3,3,3] row_mask:0xf bank_mask:0xf
    v_add_f32_dpp v25, v83, v25 quad_perm:[3,3,3,3] row_mask:0xf bank_mask:0xf
    v_add_f32_dpp v26, v87, v26 quad_perm:[3,3,3,3] row_mask:0xf bank_mask:0xf
    v_add_f32_dpp v27, v91, v27 quad_perm:[3,3,3,3] row_mask:0xf bank_mask:0xf
    v_add_f32_dpp v28, v95, v28 quad_perm:[3,3,3,3] row_mask:0xf bank_mask:0xf
    v_add_f32_dpp v29, v99, v29 quad_perm:[3,3,3,3] row_mask:0xf bank_mask:0xf
    v_add_f32_dpp v30, v103, v30 quad_perm:[3,3,3,3] row_mask:0xf bank_mask:0xf
    v_add_f32_dpp v31, v107, v31 quad_perm:[3,3,3,3] row_mask:0xf bank_mask:0xf
    v_add_f32_dpp v32, v111, v32 quad_perm:[3,3,3,3] row_mask:0xf bank_mask:0xf
    v_add_f32_dpp v33, v115, v33 quad_perm:[3,3,3,3] row_mask:0xf bank_mask:0xf
    v_add_f32_dpp v34, v119, v34 quad_perm:[3,3,3,3] row_mask:0xf bank_mask:0xf
    v_add_f32_dpp v35, v123, v35 quad_perm:[3,3,3,3] row_mask:0xf bank_mask:0xf
    v_add_f32_dpp v36, v127, v36 quad_perm:[3,3,3,3] row_mask:0xf bank_mask:0xf
    v_add_f32_dpp v37, v131, v37 quad_perm:[3,3,3,3] row_mask:0xf bank_mask:0xf
    v_add_f32_dpp v38, v135, v38 quad_perm:[3,3,3,3] row_mask:0xf bank_mask:0xf
    v_add_f32_dpp v39, v139, v39 quad_perm:[3,3,3,3] row_mask:0xf bank_mask:0xf
    v_cndmask_b32 v24, v24, v25, s[30:31]
    v_cndmask_b32 v26, v26, v27, s[30:31]
    v_cndmask_b32 v28, v28, v29, s[30:31]
    v_cndmask_b32 v30, v30, v31, s[30:31]
    v_cndmask_b32 v32, v32, v33, s[30:31]
    v_cndmask_b32 v34, v34, v35, s[30:31]
    v_cndmask_b32 v36, v36, v37, s[30:31]
    v_cndmask_b32 v38, v38, v39, s[30:31]
    v_cndmask_b32 v16, v24, v26, s[32:33]
    v_cndmask_b32 v17, v28, v30, s[32:33]
    v_cndmask_b32 v18, v32, v34, s[32:33]
    v_cndmask_b32 v19, v36, v38, s[32:33]
    s_mov_b32 s28, 0x3db504f3
    v_cvt_pk_bf16_f32 v16, v16, v16
    v_and_b32 v16, 0xffff0000, v16
    v_cvt_pk_bf16_f32 v17, v17, v17
    v_and_b32 v17, 0xffff0000, v17
    v_cvt_pk_bf16_f32 v18, v18, v18
    v_and_b32 v18, 0xffff0000, v18
    v_cvt_pk_bf16_f32 v19, v19, v19
    v_and_b32 v19, 0xffff0000, v19
    v_mul_f32 v16, s28, v16
    v_mul_f32 v17, s28, v17
    v_mul_f32 v18, s28, v18
    v_mul_f32 v19, s28, v19
    v_cvt_pk_bf16_f32 v16, v16, v16
    v_and_b32 v16, 0xffff0000, v16
    v_cvt_pk_bf16_f32 v17, v17, v17
    v_and_b32 v17, 0xffff0000, v17
    v_cvt_pk_bf16_f32 v18, v18, v18
    v_and_b32 v18, 0xffff0000, v18
    v_cvt_pk_bf16_f32 v19, v19, v19
    v_and_b32 v19, 0xffff0000, v19
    v_max3_f32 v24, v16, v17, v18
    v_max_f32 v24, v24, v19
    v_mov_b32 v25, v24
    s_nop 1
    v_permlane32_swap_b32 v24, v25
    v_max_f32 v24, v24, v25
    v_mov_b32 v25, v24
    s_nop 1
    v_permlane16_swap_b32 v24, v25
    v_max_f32 v24, v24, v25
    s_nop 1
    v_max_f32_dpp v24, v24, v24 quad_perm:[1,0,3,2] row_mask:0xf bank_mask:0xf
    s_nop 1
    v_max_f32_dpp v24, v24, v24 quad_perm:[2,3,0,1] row_mask:0xf bank_mask:0xf
    s_lshl_b32 s28, s6, 10
    v_lshlrev_b32 v22, 8, v3
    v_lshl_add_u32 v22, v1, 6, v22
    v_lshl_add_u32 v22, v2, 2, v22
    v_add_u32 v22, s28, v22
    s_mov_b32 s28, 0x3fb8aa3b
    v_sub_f32 v16, v16, v24
    v_sub_f32 v17, v17, v24
    v_sub_f32 v18, v18, v24
    v_sub_f32 v19, v19, v24
    v_mul_f32 v16, s28, v16
    v_mul_f32 v17, s28, v17
    v_mul_f32 v18, s28, v18
    v_mul_f32 v19, s28, v19
    v_exp_f32 v16, v16
    v_exp_f32 v17, v17
    v_exp_f32 v18, v18
    v_exp_f32 v19, v19
    v_cvt_pk_bf16_f32 v32, v16, v16
    v_cvt_pk_bf16_f32 v33, v17, v17
    v_cvt_pk_bf16_f32 v34, v18, v18
    v_cvt_pk_bf16_f32 v35, v19, v19
    ds_write_b32 v22, v32 offset:11520
    ds_write_b32 v22, v33 offset:11536
    ds_write_b32 v22, v34 offset:11552
    ds_write_b32 v22, v35 offset:11568
    ds_write_b32 v5, v9 offset:16352
    v_add_f32 v25, v16, v17
    v_add_f32 v25, v25, v18
    v_add_f32 v25, v25, v19
    v_mov_b32 v23, v25
    s_nop 1
    v_permlane32_swap_b32 v25, v23
    v_add_f32 v25, v25, v23
    v_mov_b32 v23, v25
    s_nop 1
    v_permlane16_swap_b32 v25, v23
    v_add_f32 v25, v25, v23
    s_nop 1
    v_add_f32_dpp v25, v25, v25 quad_perm:[1,0,3,2] row_mask:0xf bank_mask:0xf
    s_nop 1
    v_add_f32_dpp v25, v25, v25 quad_perm:[2,3,0,1] row_mask:0xf bank_mask:0xf
    v_lshlrev_b32 v26, 4, v3
    v_add_u32 v27, v5, v26
    ds_write_b32 v27, v24 offset:15616
    ds_write_b32 v27, v25 offset:15680
    ds_write_b32 v5, v9 offset:16336
    s_lshl_b32 s24, s4, 3
    s_lshr_b32 s25, s5, 2
    s_add_u32 s24, s24, s25
    s_lshl_b32 s24, s24, 6
    s_lshr_b32 s25, s6, 1
    s_lshl_b32 s25, s25, 5
    s_add_u32 s24, s24, s25
    s_and_b32 s25, s6, 1
    s_lshl_b32 s25, s25, 2
    s_add_u32 s24, s24, s25
    s_lshl_b32 s24, s24, 10
    s_and_b32 s25, s5, 3
    s_lshl_b32 s25, s25, 8
    s_add_u32 s24, s24, s25
    v_and_b32 v20, 15, v0
    v_lshlrev_b32 v20, 4, v20
    v_lshl_add_u32 v20, v1, 13, v20
    v_add_u32 v20, s24, v20
    v_mov_b32 v10, 0xffff
    v_and_b32 v11, 1, v2
    v_lshlrev_b32 v11, 4, v11
    v_lshlrev_b32 v10, v11, v10
    v_cmp_gt_u32 vcc, 2, v2
    s_nop 1
    v_cndmask_b32 v11, v10, v4, vcc
    v_cndmask_b32 v10, v4, v10, vcc
    s_mov_b32 s11, 0
L_ls_8:
    ds_read_b128 v[32:35], v4 offset:16336
    s_waitcnt lgkmcnt(0)
    v_xor_b32 v32, s9, v32
    v_xor_b32 v33, s9, v33
    v_xor_b32 v34, s9, v34
    v_xor_b32 v35, s9, v35
    v_or3_b32 v32, v32, v33, v34
    v_or_b32 v32, v32, v35
    v_cmp_ne_u32 vcc, 0, v32
    s_cbranch_vccz L_ls_8_ok
    s_sleep 1
    s_add_u32 s11, s11, 1
    s_cmp_lt_u32 s11, 2097152
    s_cbranch_scc1 L_ls_8
L_ls_8_ok:
    s_lshl_b32 s24, s6, 4
    v_mov_b32 v25, s24
    ds_read_b128 v[32:35], v25 offset:15616
    ds_read_b128 v[36:39], v25 offset:15680
    s_lshl_b32 s24, s6, 6
    v_bfe_u32 v26, v0, 2, 1
    v_lshlrev_b32 v26, 10, v26
    v_bfe_u32 v27, v0, 3, 2
    v_lshl_add_u32 v26, v27, 8, v26
    v_lshl_add_u32 v26, v2, 4, v26
    v_add_u32 v26, s24, v26
    s_lshl_b32 s24, s4, 5
    s_add_u32 s24, s24, s5
    s_lshl_b32 s24, s24, 11
    s_lshl_b32 s25, s6, 9
    s_add_u32 s24, s24, s25
    s_add_u32 s24, s24, 1048576
    v_and_b32 v27, 31, v0
    v_lshlrev_b32 v27, 4, v27
    v_add_u32 v27, s24, v27
    v_add_u32 v28, 0x800000, v27
    s_lshl_b32 s24, s4, 2
    s_add_u32 s24, s24, s7
    s_lshl_b32 s24, s24, 2
    s_add_u32 s24, s24, s6
    s_lshl_b32 s24, s24, 7
    s_add_u32 s24, s24, 229376
    s_lshl_b32 s25, s8, 4
    s_add_u32 s24, s24, s25
    v_mov_b32 v30, s24
    v_add_u32 v31, 0x800000, v30
    s_mov_b32 s24, 0x3fb8aa3b
    s_waitcnt lgkmcnt(0)
    v_max3_f32 v60, v32, v33, v34
    v_max_f32 v60, v60, v35
    v_sub_f32 v32, v32, v60
    v_sub_f32 v33, v33, v60
    v_sub_f32 v34, v34, v60
    v_sub_f32 v35, v35, v60
    v_mul_f32 v32, s24, v32
    v_mul_f32 v33, s24, v33
    v_mul_f32 v34, s24, v34
    v_mul_f32 v35, s24, v35
    v_exp_f32 v140, v32
    v_exp_f32 v142, v33
    v_exp_f32 v144, v34
    v_exp_f32 v146, v35
    v_mul_f32 v61, v140, v36
    v_fmac_f32 v61, v142, v37
    v_fmac_f32 v61, v144, v38
    v_fmac_f32 v61, v146, v39
    v_mov_b32 v62, s9
    v_mov_b32 v63, s9
    s_mov_b64 exec, 1
    global_store_dwordx4 v30, v[60:63], s[20:21]
    global_store_dwordx4 v31, v[60:63], s[20:21] sc1
    s_mov_b64 exec, -1
    v_mov_b32 v141, v140
    v_mov_b32 v143, v142
    v_mov_b32 v145, v144
    v_mov_b32 v147, v146
    s_lshl_b32 s24, s4, 16
    s_lshr_b32 s25, s5, 2
    s_lshl_b32 s25, s25, 8
    s_add_u32 s24, s24, s25
    s_lshl_b32 s25, s6, 6
    s_add_u32 s24, s24, s25
    s_add_u32 s24, s24, 1048576
    v_lshlrev_b32 v150, 14, v3
    v_lshl_add_u32 v150, v1, 12, v150
    v_lshrrev_b32 v151, 1, v2
    v_lshl_add_u32 v150, v151, 11, v150
    v_and_b32 v151, 1, v2
    v_lshl_add_u32 v150, v151, 4, v150
    v_add_u32 v150, s24, v150
    s_lshl_b32 s24, s6, 11
    v_lshlrev_b32 v152, 4, v0
    v_add_u32 v152, s24, v152
    v_lshlrev_b32 v151, 5, v3
    v_lshl_add_u32 v151, v1, 3, v151
    v_lshlrev_b32 v151, 9, v3
    v_lshl_add_u32 v151, v1, 5, v151
    v_and_b32 v31, 2, v2
    v_lshl_add_u32 v151, v31, 3, v151
    s_lshl_b32 s24, s4, 11
    s_lshl_b32 s25, s7, 7
    s_add_u32 s24, s24, s25
    s_add_u32 s24, s24, 229376
    v_add_u32 v151, s24, v151
    s_lshl_b32 s24, s6, 2
    v_lshlrev_b32 v155, 5, v0
    v_add_u32 v155, s24, v155
    s_and_b32 s28, s6, 1
    s_cmp_lt_u32 s6, 2
    s_cselect_b32 s27, 0, 524288
    s_lshl_b32 s24, s28, 7
    v_and_b32 v136, 1, v0
    v_lshlrev_b32 v136, 10, v136
    v_bfe_u32 v137, v0, 3, 2
    v_lshl_add_u32 v136, v137, 8, v136
    v_lshrrev_b32 v137, 5, v0
    v_lshl_add_u32 v136, v137, 6, v136
    v_bfe_u32 v137, v0, 1, 2
    v_lshl_add_u32 v136, v137, 4, v136
    v_add_u32 v136, s24, v136
    s_lshl_b32 s24, s4, 5
    s_add_u32 s24, s24, s5
    s_lshl_b32 s24, s24, 11
    s_lshl_b32 s25, s28, 10
    s_add_u32 s24, s24, s25
    s_add_u32 s24, s24, 2097152
    v_lshlrev_b32 v137, 4, v0
    v_add_u32 v137, s24, v137
    v_add_u32 v137, s27, v137
    s_lshl_b32 s24, s6, 5
    v_mov_b32 v138, s24
    s_lshl_b32 s24, s28, 4
    v_mov_b32 v139, s24
    v_lshlrev_b32 v135, 4, v0
    v_add_u32 v135, v135, v5
    s_and_b32 s64, s9, 0xff
    s_bfe_u32 s65, s9, 0x80008
    s_bfe_u32 s66, s9, 0x80010
    s_lshr_b32 s67, s9, 24
    s_mov_b32 s68, 0xffffff00
    s_mov_b32 s69, 0x0c0c0400
    s_mov_b32 s70, 0x04000c0c
    v_mov_b32 v154, s68
    s_mov_b32 s11, 0
L_l1_9:
    ds_read_b32 v24, v5 offset:16384
    s_waitcnt lgkmcnt(0)
    v_cmp_ne_u32 vcc, s9, v24
    s_cbranch_vccz L_l1_9_ok
    s_sleep 1
    s_add_u32 s11, s11, 1
    s_cmp_lt_u32 s11, 2097152
    s_cbranch_scc1 L_l1_9
L_l1_9_ok:
    global_load_dwordx4 v[80:83], v20, s[12:13] nt
    global_load_dwordx4 v[84:87], v20, s[12:13] offset:1024 nt
    global_load_dwordx4 v[88:91], v20, s[12:13] offset:2048 nt
    global_load_dwordx4 v[92:95], v20, s[12:13] offset:3072 nt
    s_cmp_eq_u32 s35, 1
    s_cbranch_scc0 L_K_now2
    global_load_dwordx4 v[96:99], v148, s[14:15] nt
    global_load_dwordx4 v[100:103], v148, s[14:15] offset:1024 nt
    global_load_dwordx4 v[104:107], v149, s[14:15] nt
    global_load_dwordx4 v[108:111], v149, s[14:15] offset:1024 nt
L_K_now2:
    global_load_dwordx4 v[52:55], v151, s[20:21] sc1
    s_mov_b32 s11, 0
L_ls_10:
    ds_read_b128 v[32:35], v4 offset:16448
    s_waitcnt lgkmcnt(0)
    v_xor_b32 v32, s9, v32
    v_xor_b32 v33, s9, v33
    v_xor_b32 v34, s9, v34
    v_xor_b32 v35, s9, v35
    v_or3_b32 v32, v32, v33, v34
    v_or_b32 v32, v32, v35
    v_cmp_ne_u32 vcc, 0, v32
    s_cbranch_vccz L_ls_10_ok
    s_add_u32 s11, s11, 1
    s_cmp_lt_u32 s11, 2097152
    s_cbranch_scc1 L_ls_10
L_ls_10_ok:
    ds_read_b128 v[32:35], v26 offset:17088
    ds_read_b128 v[36:39], v26 offset:19136
    ds_read_b128 v[40:43], v26 offset:21184
    ds_read_b128 v[44:47], v26 offset:23232
    s_waitcnt lgkmcnt(2)
    v_pk_mul_f32 v[60:61], v[32:33], v[140:141]
    v_pk_mul_f32 v[62:63], v[34:35], v[140:141]
    v_pk_fma_f32 v[60:61], v[36:37], v[142:143], v[60:61]
    v_pk_fma_f32 v[62:63], v[38:39], v[142:143], v[62:63]
    s_waitcnt lgkmcnt(0)
    v_pk_fma_f32 v[60:61], v[40:41], v[144:145], v[60:61]
    v_pk_fma_f32 v[62:63], v[42:43], v[144:145], v[62:63]
    v_pk_fma_f32 v[60:61], v[44:45], v[146:147], v[60:61]
    v_pk_fma_f32 v[62:63], v[46:47], v[146:147], v[62:63]
    v_and_or_b32 v60, v60, v154, s64
    v_and_or_b32 v61, v61, v154, s65
    v_and_or_b32 v62, v62, v154, s66
    v_and_or_b32 v63, v63, v154, s67
    s_mov_b32 exec_hi, 0
    global_store_dwordx4 v27, v[60:63], s[20:21]
    s_mov_b32 exec_hi, -1
    s_cmp_eq_u32 s35, 1
    s_cbranch_scc0 L_K_skipw2b
    s_mov_b32 s11, 0
L_l1_11:
    ds_read_b32 v19, v4 offset:16400
    s_waitcnt lgkmcnt(0)
    v_cmp_ne_u32 vcc, s9, v19
    s_cbranch_vccz L_l1_11_ok
    s_sleep 1
    s_add_u32 s11, s11, 1
    s_cmp_lt_u32 s11, 2097152
    s_cbranch_scc1 L_l1_11
L_l1_11_ok:
    s_mov_b32 s11, 0
L_l1_12:
    ds_read_b32 v19, v4 offset:16404
    s_waitcnt lgkmcnt(0)
    v_cmp_ne_u32 vcc, s9, v19
    s_cbranch_vccz L_l1_12_ok
    s_sleep 1
    s_add_u32 s11, s11, 1
    s_cmp_lt_u32 s11, 2097152
    s_cbranch_scc1 L_l1_12
L_l1_12_ok:
    s_lshl_b32 s24, s6, 5
    v_mul_u32_u24 v19, 144, v3
    v_lshl_add_u32 v19, v1, 2, v19
    v_add_u32 v19, s24, v19
    ds_read_b32 v112, v19 offset:15744
    ds_read_b32 v113, v19 offset:15760
    s_mov_b32 s24, 0x01000100
    s_mov_b32 s25, 0x03020302
    s_waitcnt lgkmcnt(0)
    v_perm_b32 v114, v112, v112, s24
    v_perm_b32 v115, v112, v112, s25
    v_perm_b32 v116, v113, v113, s24
    v_perm_b32 v117, v113, v113, s25
    v_and_b32 v118, v114, v10
    v_and_b32 v119, v114, v11
    v_and_b32 v120, v115, v10
    v_and_b32 v121, v115, v11
    v_and_b32 v122, v116, v10
    v_and_b32 v123, v116, v11
    v_and_b32 v124, v117, v10
    v_and_b32 v125, v117, v11
    s_waitcnt vmcnt(1)
    v_mfma_f32_16x16x16_bf16 v[64:67], v[96:97], v[118:119], 0
    v_mfma_f32_16x16x16_bf16 v[68:71], v[98:99], v[118:119], 0
    v_mfma_f32_16x16x16_bf16 v[64:67], v[100:101], v[120:121], v[64:67]
    v_mfma_f32_16x16x16_bf16 v[68:71], v[102:103], v[120:121], v[68:71]
    v_mfma_f32_16x16x16_bf16 v[64:67], v[104:105], v[122:123], v[64:67]
    v_mfma_f32_16x16x16_bf16 v[68:71], v[106:107], v[122:123], v[68:71]
    v_mfma_f32_16x16x16_bf16 v[64:67], v[108:109], v[124:125], v[64:67]
    v_mfma_f32_16x16x16_bf16 v[68:71], v[110:111], v[124:125], v[68:71]
    s_nop 6
    ds_write_b128 v152, v[64:67] offset:58112
    ds_write_b128 v152, v[68:71] offset:59136
    s_mov_b64 exec, 3
    ds_write_b32 v135, v9 offset:16592
    s_mov_b64 exec, -1
L_K_skipw2b:
    s_mov_b32 s26, 0
    s_mov_b32 s24, 0x3fb8aa3b
L_ml:
    s_waitcnt vmcnt(1)
    v_cmp_ne_u32 vcc, s9, v54
    s_cbranch_vccz L_ml_ok
    s_add_u32 s26, s26, 1
    s_cmp_eq_u32 s26, 32
    s_cselect_b32 s25, 0x800000, 0
    v_add_u32 v151, s25, v151
    global_load_dwordx4 v[52:55], v151, s[20:21] sc1
    s_waitcnt vmcnt(0)
    s_cmp_lt_u32 s26, 65536
    s_cbranch_scc1 L_ml
L_ml_ok:
    v_mov_b32 v56, v52
    v_mov_b32 v57, v56
    s_nop 1
    v_permlane32_swap_b32 v56, v57
    v_max_f32 v56, v56, v57
    v_mov_b32 v57, v56
    s_nop 1
    v_permlane16_swap_b32 v56, v57
    v_max_f32 v56, v56, v57
    s_nop 1
    v_max_f32_dpp v56, v56, v56 quad_perm:[2,3,0,1] row_mask:0xf bank_mask:0xf
    v_sub_f32 v50, v52, v56
    v_mul_f32 v50, s24, v50
    v_exp_f32 v50, v50
    s_nop 0
    v_mul_f32 v56, v50, v53
    v_mov_b32 v57, v56
    s_nop 1
    v_permlane32_swap_b32 v56, v57
    v_add_f32 v56, v56, v57
    v_mov_b32 v57, v56
    s_nop 1
    v_permlane16_swap_b32 v56, v57
    v_add_f32 v56, v56, v57
    s_nop 1
    v_add_f32_dpp v56, v56, v56 quad_perm:[2,3,0,1] row_mask:0xf bank_mask:0xf
    v_rcp_f32 v56, v56
    s_nop 0
    v_mul_f32 v50, v50, v56
    v_mov_b32 v51, v50
    s_mov_b32 s26, 0
L_op_13:
    global_load_dwordx4 v[32:35], v150, s[20:21] sc1
    global_load_dwordx4 v[36:39], v150, s[20:21] offset:32 sc1
    s_waitcnt vmcnt(0)
    v_perm_b32 v31, v33, v32, s69
    v_perm_b32 v30, v35, v34, s70
    v_or_b32 v31, v31, v30
    v_xor_b32 v31, s9, v31
    v_perm_b32 v29, v37, v36, s69
    v_perm_b32 v30, v39, v38, s70
    v_or_b32 v29, v29, v30
    v_xor_b32 v29, s9, v29
    v_or_b32 v31, v31, v29
    v_cmp_ne_u32 vcc, 0, v31
    s_nop 1
    s_and_b64 exec, exec, vcc
    s_cbranch_execz L_op_13_ok
    s_add_u32 s26, s26, 1
    s_cmp_eq_u32 s26, 32
    s_cbranch_scc0 L_op_13_c
    v_add_u32 v150, 0x800000, v150
    s_mov_b64 s[72:73], exec
    s_mov_b32 exec_lo, -1
    s_mov_b32 exec_hi, 0
    global_store_dwordx4 v28, v[60:63], s[20:21] sc1
    s_mov_b64 exec, s[72:73]
L_op_13_c:
    s_cmp_lt_u32 s26, 65536
    s_cbranch_scc1 L_op_13
L_op_13_ok:
    s_mov_b64 exec, -1
    v_and_b32 v32, s68, v32
    v_and_b32 v33, s68, v33
    v_and_b32 v34, s68, v34
    v_and_b32 v35, s68, v35
    v_and_b32 v36, s68, v36
    v_and_b32 v37, s68, v37
    v_and_b32 v38, s68, v38
    v_and_b32 v39, s68, v39
    v_pk_mul_f32 v[32:33], v[32:33], v[50:51]
    v_pk_mul_f32 v[34:35], v[34:35], v[50:51]
    v_pk_mul_f32 v[36:37], v[36:37], v[50:51]
    v_pk_mul_f32 v[38:39], v[38:39], v[50:51]
    v_permlane32_swap_b32 v32, v34
    v_permlane32_swap_b32 v33, v35
    v_permlane32_swap_b32 v36, v38
    v_permlane32_swap_b32 v37, v39
    v_add_f32 v32, v32, v34
    v_add_f32 v33, v33, v35
    v_add_f32 v36, v36, v38
    v_add_f32 v37, v37, v39
    v_permlane16_swap_b32 v32, v33
    s_nop 0
    v_permlane16_swap_b32 v36, v37
    v_add_f32 v32, v32, v33
    v_add_f32 v36, v36, v37
    s_nop 0
    v_add_f32_dpp v32, v32, v32 quad_perm:[2,3,0,1] row_mask:0xf bank_mask:0xf
    v_add_f32_dpp v36, v36, v36 quad_perm:[2,3,0,1] row_mask:0xf bank_mask:0xf
    v_cvt_pk_bf16_f32 v32, v32, v32
    v_cvt_pk_bf16_f32 v36, v36, v36
    s_nop 0
    v_and_b32_dpp v40, v32, v10 quad_perm:[0,0,0,0] row_mask:0xf bank_mask:0xf
    v_and_b32_dpp v41, v32, v11 quad_perm:[0,0,0,0] row_mask:0xf bank_mask:0xf
    v_and_b32_dpp v42, v32, v10 quad_perm:[1,1,1,1] row_mask:0xf bank_mask:0xf
    v_and_b32_dpp v43, v32, v11 quad_perm:[1,1,1,1] row_mask:0xf bank_mask:0xf
    v_and_b32_dpp v44, v36, v10 quad_perm:[0,0,0,0] row_mask:0xf bank_mask:0xf
    v_and_b32_dpp v45, v36, v11 quad_perm:[0,0,0,0] row_mask:0xf bank_mask:0xf
    v_and_b32_dpp v46, v36, v10 quad_perm:[1,1,1,1] row_mask:0xf bank_mask:0xf
    v_and_b32_dpp v47, v36, v11 quad_perm:[1,1,1,1] row_mask:0xf bank_mask:0xf
    v_mfma_f32_16x16x16_bf16 v[12:15], v[80:81], v[40:41], 0
    v_mfma_f32_16x16x16_bf16 v[16:19], v[82:83], v[40:41], 0
    v_mfma_f32_16x16x16_bf16 v[12:15], v[84:85], v[42:43], v[12:15]
    v_mfma_f32_16x16x16_bf16 v[16:19], v[86:87], v[42:43], v[16:19]
    v_mfma_f32_16x16x16_bf16 v[12:15], v[88:89], v[44:45], v[12:15]
    v_mfma_f32_16x16x16_bf16 v[16:19], v[90:91], v[44:45], v[16:19]
    v_mfma_f32_16x16x16_bf16 v[12:15], v[92:93], v[46:47], v[12:15]
    v_mfma_f32_16x16x16_bf16 v[16:19], v[94:95], v[46:47], v[16:19]
    s_nop 6
    ds_write_b128 v152, v[12:15] offset:25344
    ds_write_b128 v152, v[16:19] offset:26368
    s_mov_b64 exec, 15
    ds_write_b32 v155, v9 offset:16464
    s_mov_b64 exec, -1
    s_mov_b32 exec_hi, 0
    global_store_dwordx4 v28, v[60:63], s[20:21] sc1
    s_mov_b32 exec_hi, -1
    s_cmp_lt_u32 s6, 2
    s_cbranch_scc0 L_K_pubm
    s_mov_b32 s11, 0
L_ls_14:
    ds_read_b128 v[32:35], v138 offset:16464
    s_waitcnt lgkmcnt(0)
    v_xor_b32 v32, s9, v32
    v_xor_b32 v33, s9, v33
    v_xor_b32 v34, s9, v34
    v_xor_b32 v35, s9, v35
    v_or3_b32 v32, v32, v33, v34
    v_or_b32 v32, v32, v35
    v_cmp_ne_u32 vcc, 0, v32
    s_cbranch_vccz L_ls_14_ok
    s_add_u32 s11, s11, 1
    s_cmp_lt_u32 s11, 2097152
    s_cbranch_scc1 L_ls_14
L_ls_14_ok:
    ds_read_b128 v[32:35], v136 offset:25344
    ds_read_b128 v[36:39], v136 offset:27392
    ds_read_b128 v[40:43], v136 offset:29440
    ds_read_b128 v[44:47], v136 offset:31488
    s_waitcnt lgkmcnt(0)
    v_pk_add_f32 v[32:33], v[32:33], v[40:41]
    v_pk_add_f32 v[34:35], v[34:35], v[42:43]
    v_pk_add_f32 v[36:37], v[36:37], v[44:45]
    v_pk_add_f32 v[38:39], v[38:39], v[46:47]
    v_pk_add_f32 v[32:33], v[32:33], v[36:37]
    v_pk_add_f32 v[34:35], v[34:35], v[38:39]
    v_and_or_b32 v32, v32, v154, s64
    v_and_or_b32 v33, v33, v154, s65
    v_and_or_b32 v34, v34, v154, s66
    v_and_or_b32 v35, v35, v154, s67
    global_store_dwordx4 v137, v[32:35], s[20:21]
    ds_write_b32 v5, v9 offset:16660
    v_lshlrev_b32 v8, 2, v0
    v_add_u32 v40, v8, v138
    s_mov_b64 exec, 0xff
    ds_write_b32 v40, v4 offset:16464
    s_cmp_eq_u32 s6, 0
    s_cbranch_scc0 L_K_end0
    s_mov_b32 exec_lo, -1
    s_mov_b32 exec_hi, 15
    ds_write_b32 v8, v4 offset:16320
L_K_end0:
    s_mov_b64 exec, -1
    s_branch L_K_end
L_K_pubm:
    s_cmp_eq_u32 s35, 1
    s_cbranch_scc0 L_K_end
    s_mov_b32 s11, 0
L_ls_15:
    ds_read_b128 v[32:35], v139 offset:16592
    s_waitcnt lgkmcnt(0)
    v_xor_b32 v32, s9, v32
    v_xor_b32 v33, s9, v33
    v_xor_b32 v34, s9, v34
    v_xor_b32 v35, s9, v35
    v_or3_b32 v32, v32, v33, v34
    v_or_b32 v32, v32, v35
    v_cmp_ne_u32 vcc, 0, v32
    s_cbranch_vccz L_ls_15_ok
    s_add_u32 s11, s11, 1
    s_cmp_lt_u32 s11, 2097152
    s_cbranch_scc1 L_ls_15
L_ls_15_ok:
    ds_read_b128 v[32:35], v136 offset:58112
    ds_read_b128 v[36:39], v136 offset:60160
    ds_read_b128 v[40:43], v136 offset:62208
    ds_read_b128 v[44:47], v136 offset:64256
    s_waitcnt lgkmcnt(0)
    v_pk_add_f32 v[32:33], v[32:33], v[40:41]
    v_pk_add_f32 v[34:35], v[34:35], v[42:43]
    v_pk_add_f32 v[36:37], v[36:37], v[44:45]
    v_pk_add_f32 v[38:39], v[38:39], v[46:47]
    v_pk_add_f32 v[32:33], v[32:33], v[36:37]
    v_pk_add_f32 v[34:35], v[34:35], v[38:39]
    v_and_or_b32 v32, v32, v154, s64
    v_and_or_b32 v33, v33, v154, s65
    v_and_or_b32 v34, v34, v154, s66
    v_and_or_b32 v35, v35, v154, s67
    global_store_dwordx4 v137, v[32:35], s[20:21]
    v_add_u32 v137, 0x800000, v137
    global_store_dwordx4 v137, v[32:35], s[20:21] sc1
    v_mov_b32 v40, 0
    v_mov_b32 v41, 0
    v_mov_b32 v42, 0
    v_mov_b32 v43, 0
    ds_write_b128 v139, v[40:43] offset:16592
L_K_end:
    s_endpgm
L_V:
    s_cmp_eq_u32 s6, 0
    s_cbranch_scc0 L_V_noln
    s_setprio 3
    v_lshlrev_b32 v4, 6, v0
    s_waitcnt lgkmcnt(0)
    global_load_dwordx4 v[16:19], v4, s[36:37] offset:0
    global_load_dwordx4 v[20:23], v4, s[36:37] offset:16
    global_load_dwordx4 v[24:27], v4, s[36:37] offset:32
    global_load_dwordx4 v[28:31], v4, s[36:37] offset:48
    s_load_dword s9, s[60:61], 49152
    s_waitcnt vmcnt(0)
    v_lshlrev_b32 v32, 16, v16
    v_and_b32 v33, 0xffff0000, v16
    v_lshlrev_b32 v34, 16, v17
    v_and_b32 v35, 0xffff0000, v17
    v_lshlrev_b32 v36, 16, v18
    v_and_b32 v37, 0xffff0000, v18
    v_lshlrev_b32 v38, 16, v19
    v_and_b32 v39, 0xffff0000, v19
    v_lshlrev_b32 v40, 16, v20
    v_and_b32 v41, 0xffff0000, v20
    v_lshlrev_b32 v42, 16, v21
    v_and_b32 v43, 0xffff0000, v21
    v_lshlrev_b32 v44, 16, v22
    v_and_b32 v45, 0xffff0000, v22
    v_lshlrev_b32 v46, 16, v23
    v_and_b32 v47, 0xffff0000, v23
    v_lshlrev_b32 v48, 16, v24
    v_and_b32 v49, 0xffff0000, v24
    v_lshlrev_b32 v50, 16, v25
    v_and_b32 v51, 0xffff0000, v25
    v_lshlrev_b32 v52, 16, v26
    v_and_b32 v53, 0xffff0000, v26
    v_lshlrev_b32 v54, 16, v27
    v_and_b32 v55, 0xffff0000, v27
    v_lshlrev_b32 v56, 16, v28
    v_and_b32 v57, 0xffff0000, v28
    v_lshlrev_b32 v58, 16, v29
    v_and_b32 v59, 0xffff0000, v29
    v_lshlrev_b32 v60, 16, v30
    v_and_b32 v61, 0xffff0000, v30
    v_lshlrev_b32 v62, 16, v31
    v_and_b32 v63, 0xffff0000, v31
    v_pk_add_f32 v[64:65], v[32:33], v[34:35]
    v_pk_add_f32 v[66:67], v[36:37], v[38:39]
    v_pk_add_f32 v[68:69], v[40:41], v[42:43]
    v_pk_add_f32 v[70:71], v[44:45], v[46:47]
    v_pk_add_f32 v[72:73], v[48:49], v[50:51]
    v_pk_add_f32 v[74:75], v[52:53], v[54:55]
    v_pk_add_f32 v[76:77], v[56:57], v[58:59]
    v_pk_add_f32 v[78:79], v[60:61], v[62:63]
    v_pk_add_f32 v[64:65], v[64:65], v[72:73]
    v_pk_add_f32 v[66:67], v[66:67], v[74:75]
    v_pk_add_f32 v[68:69], v[68:69], v[76:77]
    v_pk_add_f32 v[70:71], v[70:71], v[78:79]
    v_pk_add_f32 v[64:65], v[64:65], v[68:69]
    v_pk_add_f32 v[66:67], v[66:67], v[70:71]
    v_pk_add_f32 v[64:65], v[64:65], v[66:67]
    v_add_f32 v80, v64, v65
    s_nop 1
    v_add_f32_dpp v80, v80, v80 row_ror:8 row_mask:0xf bank_mask:0xf
    s_nop 1
    v_add_f32_dpp v80, v80, v80 row_ror:4 row_mask:0xf bank_mask:0xf
    s_nop 1
    v_add_f32_dpp v80, v80, v80 row_ror:2 row_mask:0xf bank_mask:0xf
    s_nop 1
    v_add_f32_dpp v80, v80, v80 row_ror:1 row_mask:0xf bank_mask:0xf
    v_mul_f32 v80, 0xbb000000, v80
    v_mov_b32 v81, v80
    v_pk_add_f32 v[72:73], v[32:33], v[80:81]
    v_pk_add_f32 v[74:75], v[34:35], v[80:81]
    v_pk_add_f32 v[76:77], v[36:37], v[80:81]
    v_pk_add_f32 v[78:79], v[38:39], v[80:81]
    v_pk_mul_f32 v[64:65], v[72:73], v[72:73]
    v_pk_mul_f32 v[66:67], v[74:75], v[74:75]
    v_pk_mul_f32 v[68:69], v[76:77], v[76:77]
    v_pk_mul_f32 v[70:71], v[78:79], v[78:79]
    v_pk_add_f32 v[72:73], v[40:41], v[80:81]
    v_pk_add_f32 v[74:75], v[42:43], v[80:81]
    v_pk_add_f32 v[76:77], v[44:45], v[80:81]
    v_pk_add_f32 v[78:79], v[46:47], v[80:81]
    v_pk_fma_f32 v[64:65], v[72:73], v[72:73], v[64:65]
    v_pk_fma_f32 v[66:67], v[74:75], v[74:75], v[66:67]
    v_pk_fma_f32 v[68:69], v[76:77], v[76:77], v[68:69]
    v_pk_fma_f32 v[70:71], v[78:79], v[78:79], v[70:71]
    v_pk_add_f32 v[72:73], v[48:49], v[80:81]
    v_pk_add_f32 v[74:75], v[50:51], v[80:81]
    v_pk_add_f32 v[76:77], v[52:53], v[80:81]
    v_pk_add_f32 v[78:79], v[54:55], v[80:81]
    v_pk_fma_f32 v[64:65], v[72:73], v[72:73], v[64:65]
    v_pk_fma_f32 v[66:67], v[74:75], v[74:75], v[66:67]
    v_pk_fma_f32 v[68:69], v[76:77], v[76:77], v[68:69]
    v_pk_fma_f32 v[70:71], v[78:79], v[78:79], v[70:71]
    v_pk_add_f32 v[72:73], v[56:57], v[80:81]
    v_pk_add_f32 v[74:75], v[58:59], v[80:81]
    v_pk_add_f32 v[76:77], v[60:61], v[80:81]
    v_pk_add_f32 v[78:79], v[62:63], v[80:81]
    v_pk_fma_f32 v[64:65], v[72:73], v[72:73], v[64:65]
    v_pk_fma_f32 v[66:67], v[74:75], v[74:75], v[66:67]
    v_pk_fma_f32 v[68:69], v[76:77], v[76:77], v[68:69]
    v_pk_fma_f32 v[70:71], v[78:79], v[78:79], v[70:71]
    v_pk_add_f32 v[64:65], v[64:65], v[68:69]
    v_pk_add_f32 v[66:67], v[66:67], v[70:71]
    v_pk_add_f32 v[64:65], v[64:65], v[66:67]
    v_add_f32 v82, v64, v65
    s_nop 1
    v_add_f32_dpp v82, v82, v82 row_ror:8 row_mask:0xf bank_mask:0xf
    s_nop 1
    v_add_f32_dpp v82, v82, v82 row_ror:4 row_mask:0xf bank_mask:0xf
    s_nop 1
    v_add_f32_dpp v82, v82, v82 row_ror:2 row_mask:0xf bank_mask:0xf
    s_nop 1
    v_add_f32_dpp v82, v82, v82 row_ror:1 row_mask:0xf bank_mask:0xf
    v_mul_f32 v82, 0x3b000000, v82
    v_cvt_pk_bf16_f32 v82, v82, v82
    v_and_b32 v82, 0xffff0000, v82
    v_add_f32 v82, 0x3727c5ac, v82
    v_cvt_pk_bf16_f32 v82, v82, v82
    v_and_b32 v82, 0xffff0000, v82
    v_sqrt_f32 v82, v82
    s_nop 0
    v_cvt_pk_bf16_f32 v82, v82, v82
    v_and_b32 v82, 0xffff0000, v82
    v_rcp_f32 v84, v82
    v_cvt_pk_bf16_f32 v80, v80, v80
    v_and_b32 v80, 0xffff0000, v80
    v_mov_b32 v81, v80
    v_mov_b32 v85, v84
    v_pk_add_f32 v[64:65], v[32:33], v[80:81]
    v_pk_add_f32 v[66:67], v[34:35], v[80:81]
    v_pk_add_f32 v[68:69], v[36:37], v[80:81]
    v_pk_add_f32 v[70:71], v[38:39], v[80:81]
    v_cvt_pk_bf16_f32 v72, v64, v65
    v_cvt_pk_bf16_f32 v73, v66, v67
    v_cvt_pk_bf16_f32 v74, v68, v69
    v_cvt_pk_bf16_f32 v75, v70, v71
    v_lshlrev_b32 v64, 16, v72
    v_and_b32 v65, 0xffff0000, v72
    v_lshlrev_b32 v66, 16, v73
    v_and_b32 v67, 0xffff0000, v73
    v_lshlrev_b32 v68, 16, v74
    v_and_b32 v69, 0xffff0000, v74
    v_lshlrev_b32 v70, 16, v75
    v_and_b32 v71, 0xffff0000, v75
    v_pk_mul_f32 v[64:65], v[64:65], v[84:85]
    v_pk_mul_f32 v[66:67], v[66:67], v[84:85]
    v_pk_mul_f32 v[68:69], v[68:69], v[84:85]
    v_pk_mul_f32 v[70:71], v[70:71], v[84:85]
    v_cvt_pk_bf16_f32 v96, v64, v65
    v_cvt_pk_bf16_f32 v97, v66, v67
    v_cvt_pk_bf16_f32 v100, v68, v69
    v_cvt_pk_bf16_f32 v101, v70, v71
    v_pk_add_f32 v[64:65], v[40:41], v[80:81]
    v_pk_add_f32 v[66:67], v[42:43], v[80:81]
    v_pk_add_f32 v[68:69], v[44:45], v[80:81]
    v_pk_add_f32 v[70:71], v[46:47], v[80:81]
    v_cvt_pk_bf16_f32 v72, v64, v65
    v_cvt_pk_bf16_f32 v73, v66, v67
    v_cvt_pk_bf16_f32 v74, v68, v69
    v_cvt_pk_bf16_f32 v75, v70, v71
    v_lshlrev_b32 v64, 16, v72
    v_and_b32 v65, 0xffff0000, v72
    v_lshlrev_b32 v66, 16, v73
    v_and_b32 v67, 0xffff0000, v73
    v_lshlrev_b32 v68, 16, v74
    v_and_b32 v69, 0xffff0000, v74
    v_lshlrev_b32 v70, 16, v75
    v_and_b32 v71, 0xffff0000, v75
    v_pk_mul_f32 v[64:65], v[64:65], v[84:85]
    v_pk_mul_f32 v[66:67], v[66:67], v[84:85]
    v_pk_mul_f32 v[68:69], v[68:69], v[84:85]
    v_pk_mul_f32 v[70:71], v[70:71], v[84:85]
    v_cvt_pk_bf16_f32 v104, v64, v65
    v_cvt_pk_bf16_f32 v105, v66, v67
    v_cvt_pk_bf16_f32 v108, v68, v69
    v_cvt_pk_bf16_f32 v109, v70, v71
    v_pk_add_f32 v[64:65], v[48:49], v[80:81]
    v_pk_add_f32 v[66:67], v[50:51], v[80:81]
    v_pk_add_f32 v[68:69], v[52:53], v[80:81]
    v_pk_add_f32 v[70:71], v[54:55], v[80:81]
    v_cvt_pk_bf16_f32 v72, v64, v65
    v_cvt_pk_bf16_f32 v73, v66, v67
    v_cvt_pk_bf16_f32 v74, v68, v69
    v_cvt_pk_bf16_f32 v75, v70, v71
    v_lshlrev_b32 v64, 16, v72
    v_and_b32 v65, 0xffff0000, v72
    v_lshlrev_b32 v66, 16, v73
    v_and_b32 v67, 0xffff0000, v73
    v_lshlrev_b32 v68, 16, v74
    v_and_b32 v69, 0xffff0000, v74
    v_lshlrev_b32 v70, 16, v75
    v_and_b32 v71, 0xffff0000, v75
    v_pk_mul_f32 v[64:65], v[64:65], v[84:85]
    v_pk_mul_f32 v[66:67], v[66:67], v[84:85]
    v_pk_mul_f32 v[68:69], v[68:69], v[84:85]
    v_pk_mul_f32 v[70:71], v[70:71], v[84:85]
    v_cvt_pk_bf16_f32 v98, v64, v65
    v_cvt_pk_bf16_f32 v99, v66, v67
    v_cvt_pk_bf16_f32 v102, v68, v69
    v_cvt_pk_bf16_f32 v103, v70, v71
    v_pk_add_f32 v[64:65], v[56:57], v[80:81]
    v_pk_add_f32 v[66:67], v[58:59], v[80:81]
    v_pk_add_f32 v[68:69], v[60:61], v[80:81]
    v_pk_add_f32 v[70:71], v[62:63], v[80:81]
    v_cvt_pk_bf16_f32 v72, v64, v65
    v_cvt_pk_bf16_f32 v73, v66, v67
    v_cvt_pk_bf16_f32 v74, v68, v69
    v_cvt_pk_bf16_f32 v75, v70, v71
    v_lshlrev_b32 v64, 16, v72
    v_and_b32 v65, 0xffff0000, v72
    v_lshlrev_b32 v66, 16, v73
    v_and_b32 v67, 0xffff0000, v73
    v_lshlrev_b32 v68, 16, v74
    v_and_b32 v69, 0xffff0000, v74
    v_lshlrev_b32 v70, 16, v75
    v_and_b32 v71, 0xffff0000, v75
    v_pk_mul_f32 v[64:65], v[64:65], v[84:85]
    v_pk_mul_f32 v[66:67], v[66:67], v[84:85]
    v_pk_mul_f32 v[68:69], v[68:69], v[84:85]
    v_pk_mul_f32 v[70:71], v[70:71], v[84:85]
    v_cvt_pk_bf16_f32 v106, v64, v65
    v_cvt_pk_bf16_f32 v107, v66, v67
    v_cvt_pk_bf16_f32 v110, v68, v69
    v_cvt_pk_bf16_f32 v111, v70, v71
    ds_write_b128 v4, v[96:99] offset:0
    ds_write_b128 v4, v[100:103] offset:16
    ds_write_b128 v4, v[104:107] offset:32
    ds_write_b128 v4, v[108:111] offset:48
    s_waitcnt lgkmcnt(0)
    s_mul_i32 s9, s9, 0x915f77f5
    s_add_u32 s9, s9, 0x3c6ef35d
    s_or_b32 s9, s9, 1
    v_mov_b32 v8, 0
    v_mov_b32 v9, s9
    ds_write_b32 v8, v9 offset:16408
    s_lshl_b32 s26, s4, 2
    s_lshr_b32 s24, 0x44044444, s26
    s_and_b32 s24, s24, 15
    s_lshl_b32 s24, s24, 2
    s_mov_b32 s25, 0x18141410
    s_cmp_lt_u32 s4, 4
    s_cselect_b32 s25, 0xc080400, s25
    s_and_b32 s26, s4, 3
    s_lshl_b32 s26, s26, 3
    s_lshr_b32 s25, s25, s26
    s_and_b32 s25, s25, 0xff
    s_lshl_b32 s25, s25, 2
    s_cmp_lt_u32 s5, s24
    s_cbranch_scc0 L_V_ln_done
    v_mov_b32 v16, v96
    v_mov_b32 v17, v97
    v_mov_b32 v18, v100
    v_mov_b32 v19, v101
    v_mov_b32 v20, v104
    v_mov_b32 v21, v105
    v_mov_b32 v22, v108
    v_mov_b32 v23, v109
    v_mov_b32 v24, v98
    v_mov_b32 v25, v99
    v_mov_b32 v26, v102
    v_mov_b32 v27, v103
    v_mov_b32 v28, v106
    v_mov_b32 v29, v107
    v_mov_b32 v30, v110
    v_mov_b32 v31, v111
    v_lshlrev_b32 v32, 16, v16
    v_and_b32 v33, 0xffff0000, v16
    v_lshlrev_b32 v34, 16, v17
    v_and_b32 v35, 0xffff0000, v17
    v_lshlrev_b32 v36, 16, v18
    v_and_b32 v37, 0xffff0000, v18
    v_lshlrev_b32 v38, 16, v19
    v_and_b32 v39, 0xffff0000, v19
    v_lshlrev_b32 v40, 16, v20
    v_and_b32 v41, 0xffff0000, v20
    v_lshlrev_b32 v42, 16, v21
    v_and_b32 v43, 0xffff0000, v21
    v_lshlrev_b32 v44, 16, v22
    v_and_b32 v45, 0xffff0000, v22
    v_lshlrev_b32 v46, 16, v23
    v_and_b32 v47, 0xffff0000, v23
    v_lshlrev_b32 v48, 16, v24
    v_and_b32 v49, 0xffff0000, v24
    v_lshlrev_b32 v50, 16, v25
    v_and_b32 v51, 0xffff0000, v25
    v_lshlrev_b32 v52, 16, v26
    v_and_b32 v53, 0xffff0000, v26
    v_lshlrev_b32 v54, 16, v27
    v_and_b32 v55, 0xffff0000, v27
    v_lshlrev_b32 v56, 16, v28
    v_and_b32 v57, 0xffff0000, v28
    v_lshlrev_b32 v58, 16, v29
    v_and_b32 v59, 0xffff0000, v29
    v_lshlrev_b32 v60, 16, v30
    v_and_b32 v61, 0xffff0000, v30
    v_lshlrev_b32 v62, 16, v31
    v_and_b32 v63, 0xffff0000, v31
    v_pk_add_f32 v[64:65], v[32:33], v[34:35]
    v_pk_add_f32 v[66:67], v[36:37], v[38:39]
    v_pk_add_f32 v[68:69], v[40:41], v[42:43]
    v_pk_add_f32 v[70:71], v[44:45], v[46:47]
    v_pk_add_f32 v[72:73], v[48:49], v[50:51]
    v_pk_add_f32 v[74:75], v[52:53], v[54:55]
    v_pk_add_f32 v[76:77], v[56:57], v[58:59]
    v_pk_add_f32 v[78:79], v[60:61], v[62:63]
    v_pk_add_f32 v[64:65], v[64:65], v[72:73]
    v_pk_add_f32 v[66:67], v[66:67], v[74:75]
    v_pk_add_f32 v[68:69], v[68:69], v[76:77]
    v_pk_add_f32 v[70:71], v[70:71], v[78:79]
    v_pk_add_f32 v[64:65], v[64:65], v[68:69]
    v_pk_add_f32 v[66:67], v[66:67], v[70:71]
    v_pk_add_f32 v[64:65], v[64:65], v[66:67]
    v_add_f32 v80, v64, v65
    s_nop 1
    v_add_f32_dpp v80, v80, v80 row_ror:8 row_mask:0xf bank_mask:0xf
    s_nop 1
    v_add_f32_dpp v80, v80, v80 row_ror:4 row_mask:0xf bank_mask:0xf
    s_nop 1
    v_add_f32_dpp v80, v80, v80 row_ror:2 row_mask:0xf bank_mask:0xf
    s_nop 1
    v_add_f32_dpp v80, v80, v80 row_ror:1 row_mask:0xf bank_mask:0xf
    v_mul_f32 v80, 0xbb000000, v80
    v_mov_b32 v81, v80
    v_pk_add_f32 v[72:73], v[32:33], v[80:81]
    v_pk_add_f32 v[74:75], v[34:35], v[80:81]
    v_pk_add_f32 v[76:77], v[36:37], v[80:81]
    v_pk_add_f32 v[78:79], v[38:39], v[80:81]
    v_pk_mul_f32 v[64:65], v[72:73], v[72:73]
    v_pk_mul_f32 v[66:67], v[74:75], v[74:75]
    v_pk_mul_f32 v[68:69], v[76:77], v[76:77]
    v_pk_mul_f32 v[70:71], v[78:79], v[78:79]
    v_pk_add_f32 v[72:73], v[40:41], v[80:81]
    v_pk_add_f32 v[74:75], v[42:43], v[80:81]
    v_pk_add_f32 v[76:77], v[44:45], v[80:81]
    v_pk_add_f32 v[78:79], v[46:47], v[80:81]
    v_pk_fma_f32 v[64:65], v[72:73], v[72:73], v[64:65]
    v_pk_fma_f32 v[66:67], v[74:75], v[74:75], v[66:67]
    v_pk_fma_f32 v[68:69], v[76:77], v[76:77], v[68:69]
    v_pk_fma_f32 v[70:71], v[78:79], v[78:79], v[70:71]
    v_pk_add_f32 v[72:73], v[48:49], v[80:81]
    v_pk_add_f32 v[74:75], v[50:51], v[80:81]
    v_pk_add_f32 v[76:77], v[52:53], v[80:81]
    v_pk_add_f32 v[78:79], v[54:55], v[80:81]
    v_pk_fma_f32 v[64:65], v[72:73], v[72:73], v[64:65]
    v_pk_fma_f32 v[66:67], v[74:75], v[74:75], v[66:67]
    v_pk_fma_f32 v[68:69], v[76:77], v[76:77], v[68:69]
    v_pk_fma_f32 v[70:71], v[78:79], v[78:79], v[70:71]
    v_pk_add_f32 v[72:73], v[56:57], v[80:81]
    v_pk_add_f32 v[74:75], v[58:59], v[80:81]
    v_pk_add_f32 v[76:77], v[60:61], v[80:81]
    v_pk_add_f32 v[78:79], v[62:63], v[80:81]
    v_pk_fma_f32 v[64:65], v[72:73], v[72:73], v[64:65]
    v_pk_fma_f32 v[66:67], v[74:75], v[74:75], v[66:67]
    v_pk_fma_f32 v[68:69], v[76:77], v[76:77], v[68:69]
    v_pk_fma_f32 v[70:71], v[78:79], v[78:79], v[70:71]
    v_pk_add_f32 v[64:65], v[64:65], v[68:69]
    v_pk_add_f32 v[66:67], v[66:67], v[70:71]
    v_pk_add_f32 v[64:65], v[64:65], v[66:67]
    v_add_f32 v82, v64, v65
    s_nop 1
    v_add_f32_dpp v82, v82, v82 row_ror:8 row_mask:0xf bank_mask:0xf
    s_nop 1
    v_add_f32_dpp v82, v82, v82 row_ror:4 row_mask:0xf bank_mask:0xf
    s_nop 1
    v_add_f32_dpp v82, v82, v82 row_ror:2 row_mask:0xf bank_mask:0xf
    s_nop 1
    v_add_f32_dpp v82, v82, v82 row_ror:1 row_mask:0xf bank_mask:0xf
    v_mul_f32 v82, 0x3b000000, v82
    v_cvt_pk_bf16_f32 v82, v82, v82
    v_and_b32 v82, 0xffff0000, v82
    v_add_f32 v82, 0x3727c5ac, v82
    v_cvt_pk_bf16_f32 v82, v82, v82
    v_and_b32 v82, 0xffff0000, v82
    v_sqrt_f32 v82, v82
    s_nop 0
    v_cvt_pk_bf16_f32 v82, v82, v82
    v_and_b32 v82, 0xffff0000, v82
    v_rcp_f32 v84, v82
    v_cvt_pk_bf16_f32 v80, v80, v80
    v_and_b32 v80, 0xffff0000, v80
    v_mov_b32 v81, v80
    v_mov_b32 v85, v84
    v_pk_add_f32 v[64:65], v[32:33], v[80:81]
    v_pk_add_f32 v[66:67], v[34:35], v[80:81]
    v_pk_add_f32 v[68:69], v[36:37], v[80:81]
    v_pk_add_f32 v[70:71], v[38:39], v[80:81]
    v_cvt_pk_bf16_f32 v72, v64, v65
    v_cvt_pk_bf16_f32 v73, v66, v67
    v_cvt_pk_bf16_f32 v74, v68, v69
    v_cvt_pk_bf16_f32 v75, v70, v71
    v_lshlrev_b32 v64, 16, v72
    v_and_b32 v65, 0xffff0000, v72
    v_lshlrev_b32 v66, 16, v73
    v_and_b32 v67, 0xffff0000, v73
    v_lshlrev_b32 v68, 16, v74
    v_and_b32 v69, 0xffff0000, v74
    v_lshlrev_b32 v70, 16, v75
    v_and_b32 v71, 0xffff0000, v75
    v_pk_mul_f32 v[64:65], v[64:65], v[84:85]
    v_pk_mul_f32 v[66:67], v[66:67], v[84:85]
    v_pk_mul_f32 v[68:69], v[68:69], v[84:85]
    v_pk_mul_f32 v[70:71], v[70:71], v[84:85]
    v_cvt_pk_bf16_f32 v96, v64, v65
    v_cvt_pk_bf16_f32 v97, v66, v67
    v_cvt_pk_bf16_f32 v100, v68, v69
    v_cvt_pk_bf16_f32 v101, v70, v71
    v_pk_add_f32 v[64:65], v[40:41], v[80:81]
    v_pk_add_f32 v[66:67], v[42:43], v[80:81]
    v_pk_add_f32 v[68:69], v[44:45], v[80:81]
    v_pk_add_f32 v[70:71], v[46:47], v[80:81]
    v_cvt_pk_bf16_f32 v72, v64, v65
    v_cvt_pk_bf16_f32 v73, v66, v67
    v_cvt_pk_bf16_f32 v74, v68, v69
    v_cvt_pk_bf16_f32 v75, v70, v71
    v_lshlrev_b32 v64, 16, v72
    v_and_b32 v65, 0xffff0000, v72
    v_lshlrev_b32 v66, 16, v73
    v_and_b32 v67, 0xffff0000, v73
    v_lshlrev_b32 v68, 16, v74
    v_and_b32 v69, 0xffff0000, v74
    v_lshlrev_b32 v70, 16, v75
    v_and_b32 v71, 0xffff0000, v75
    v_pk_mul_f32 v[64:65], v[64:65], v[84:85]
    v_pk_mul_f32 v[66:67], v[66:67], v[84:85]
    v_pk_mul_f32 v[68:69], v[68:69], v[84:85]
    v_pk_mul_f32 v[70:71], v[70:71], v[84:85]
    v_cvt_pk_bf16_f32 v104, v64, v65
    v_cvt_pk_bf16_f32 v105, v66, v67
    v_cvt_pk_bf16_f32 v108, v68, v69
    v_cvt_pk_bf16_f32 v109, v70, v71
    v_pk_add_f32 v[64:65], v[48:49], v[80:81]
    v_pk_add_f32 v[66:67], v[50:51], v[80:81]
    v_pk_add_f32 v[68:69], v[52:53], v[80:81]
    v_pk_add_f32 v[70:71], v[54:55], v[80:81]
    v_cvt_pk_bf16_f32 v72, v64, v65
    v_cvt_pk_bf16_f32 v73, v66, v67
    v_cvt_pk_bf16_f32 v74, v68, v69
    v_cvt_pk_bf16_f32 v75, v70, v71
    v_lshlrev_b32 v64, 16, v72
    v_and_b32 v65, 0xffff0000, v72
    v_lshlrev_b32 v66, 16, v73
    v_and_b32 v67, 0xffff0000, v73
    v_lshlrev_b32 v68, 16, v74
    v_and_b32 v69, 0xffff0000, v74
    v_lshlrev_b32 v70, 16, v75
    v_and_b32 v71, 0xffff0000, v75
    v_pk_mul_f32 v[64:65], v[64:65], v[84:85]
    v_pk_mul_f32 v[66:67], v[66:67], v[84:85]
    v_pk_mul_f32 v[68:69], v[68:69], v[84:85]
    v_pk_mul_f32 v[70:71], v[70:71], v[84:85]
    v_cvt_pk_bf16_f32 v98, v64, v65
    v_cvt_pk_bf16_f32 v99, v66, v67
    v_cvt_pk_bf16_f32 v102, v68, v69
    v_cvt_pk_bf16_f32 v103, v70, v71
    v_pk_add_f32 v[64:65], v[56:57], v[80:81]
    v_pk_add_f32 v[66:67], v[58:59], v[80:81]
    v_pk_add_f32 v[68:69], v[60:61], v[80:81]
    v_pk_add_f32 v[70:71], v[62:63], v[80:81]
    v_cvt_pk_bf16_f32 v72, v64, v65
    v_cvt_pk_bf16_f32 v73, v66, v67
    v_cvt_pk_bf16_f32 v74, v68, v69
    v_cvt_pk_bf16_f32 v75, v70, v71
    v_lshlrev_b32 v64, 16, v72
    v_and_b32 v65, 0xffff0000, v72
    v_lshlrev_b32 v66, 16, v73
    v_and_b32 v67, 0xffff0000, v73
    v_lshlrev_b32 v68, 16, v74
    v_and_b32 v69, 0xffff0000, v74
    v_lshlrev_b32 v70, 16, v75
    v_and_b32 v71, 0xffff0000, v75
    v_pk_mul_f32 v[64:65], v[64:65], v[84:85]
    v_pk_mul_f32 v[66:67], v[66:67], v[84:85]
    v_pk_mul_f32 v[68:69], v[68:69], v[84:85]
    v_pk_mul_f32 v[70:71], v[70:71], v[84:85]
    v_cvt_pk_bf16_f32 v106, v64, v65
    v_cvt_pk_bf16_f32 v107, v66, v67
    v_cvt_pk_bf16_f32 v110, v68, v69
    v_cvt_pk_bf16_f32 v111, v70, v71
    ds_write_b128 v4, v[96:99] offset:4096
    ds_write_b128 v4, v[100:103] offset:4112
    ds_write_b128 v4, v[104:107] offset:4128
    ds_write_b128 v4, v[108:111] offset:4144
    ds_write_b32 v8, v9 offset:16412
L_V_ln_done:
    s_setprio 1
    s_lshl_b32 s10, s7, 24
    s_lshl_b32 s11, s4, 21
    s_add_u32 s10, s10, s11
    s_lshl_b32 s11, s8, 16
    s_add_u32 s10, s10, s11
    s_add_u32 s10, s10, 1572864
    s_mul_i32 s18, s5, 2
    s_lshl_b32 s11, s6, 4
    s_add_u32 s18, s18, s11
    v_lshrrev_b32 v1, 4, v0
    v_and_b32 v2, 3, v0
    v_bfe_u32 v3, v0, 2, 2
    v_mov_b32 v4, 0
    s_lshl_b32 s28, s6, 2
    v_mov_b32 v5, s28
    s_waitcnt lgkmcnt(0)
    s_mov_b64 s[12:13], s[44:45]
    s_mov_b64 s[14:15], s[52:53]
    s_mov_b64 s[16:17], s[56:57]
    s_mov_b64 s[20:21], s[60:61]
    s_add_u32 s22, s40, s10
    s_addc_u32 s23, s41, 0
    s_branch L_V_go
L_V_noln:
    s_setprio 1
    s_lshl_b32 s10, s7, 24
    s_lshl_b32 s11, s4, 21
    s_add_u32 s10, s10, s11
    s_lshl_b32 s11, s8, 16
    s_add_u32 s10, s10, s11
    s_add_u32 s10, s10, 1572864
    s_mul_i32 s18, s5, 2
    s_lshl_b32 s11, s6, 4
    s_add_u32 s18, s18, s11
    v_lshrrev_b32 v1, 4, v0
    v_and_b32 v2, 3, v0
    v_bfe_u32 v3, v0, 2, 2
    v_mov_b32 v4, 0
    s_lshl_b32 s28, s6, 2
    v_mov_b32 v5, s28
    s_waitcnt lgkmcnt(0)
    s_mov_b64 s[12:13], s[44:45]
    s_mov_b64 s[14:15], s[52:53]
    s_mov_b64 s[16:17], s[56:57]
    s_mov_b64 s[20:21], s[60:61]
    s_add_u32 s22, s40, s10
    s_addc_u32 s23, s41, 0
    s_load_dword s9, s[20:21], 49152
    s_waitcnt lgkmcnt(0)
    s_mul_i32 s9, s9, 0x915f77f5
    s_add_u32 s9, s9, 0x3c6ef35d
    s_or_b32 s9, s9, 1
L_V_go:
    v_lshlrev_b32 v6, 4, v0
    s_add_u32 s34, s6, 4
    v_mov_b32 v9, s9
    s_and_b32 s64, s9, 0xff
    s_bfe_u32 s65, s9, 0x80008
    s_bfe_u32 s66, s9, 0x80010
    s_lshr_b32 s67, s9, 24
    s_mov_b32 s68, 0xffffff00
    s_mov_b32 s69, 0x0c0c0400
    s_mov_b32 s70, 0x04000c0c
    v_mov_b32 v10, 0xffff
    v_and_b32 v11, 1, v2
    v_lshlrev_b32 v11, 4, v11
    v_lshlrev_b32 v10, v11, v10
    v_cmp_gt_u32 vcc, 2, v2
    s_nop 1
    v_cndmask_b32 v11, v10, v4, vcc
    v_cndmask_b32 v10, v4, v10, vcc
    s_lshl_b32 s24, s6, 7
    v_and_b32 v146, 1, v0
    v_lshlrev_b32 v146, 10, v146
    v_bfe_u32 v147, v0, 3, 2
    v_lshl_add_u32 v146, v147, 8, v146
    v_lshrrev_b32 v147, 5, v0
    v_lshl_add_u32 v146, v147, 6, v146
    v_bfe_u32 v147, v0, 1, 2
    v_lshl_add_u32 v146, v147, 4, v146
    v_add_u32 v146, s24, v146
    s_lshl_b32 s24, s4, 5
    s_add_u32 s24, s24, s5
    s_lshl_b32 s24, s24, 11
    s_lshl_b32 s25, s6, 10
    s_add_u32 s24, s24, s25
    s_add_u32 s24, s24, 2097152
    v_lshlrev_b32 v147, 4, v0
    v_add_u32 v147, s24, v147
    v_mov_b32 v154, s68
    s_lshl_b32 s24, s6, 5
    s_add_u32 s24, s24, 64
    v_mov_b32 v145, s24
    s_lshl_b32 s28, s6, 10
    v_lshlrev_b32 v8, 8, v3
    v_lshl_add_u32 v8, v1, 6, v8
    v_add_u32 v8, s28, v8
    s_lshl_b32 s24, s6, 11
    v_lshlrev_b32 v153, 4, v0
    v_add_u32 v153, s24, v153
    s_mov_b32 s11, 0
L_cr_16:
    ds_read_b32 v12, v5 offset:16368
    s_waitcnt lgkmcnt(0)
    v_subrev_u32 v12, s9, v12
    v_subrev_u32 v12, 2, v12
    v_cmp_lt_u32 vcc, 8, v12
    s_cbranch_vccz L_cr_16_ok
    s_sleep 1
    s_add_u32 s11, s11, 1
    s_cmp_lt_u32 s11, 2097152
    s_cbranch_scc1 L_cr_16
L_cr_16_ok:
    s_add_u32 s10, s18, 0
    s_and_b32 s10, s10, 63
    s_lshl_b32 s10, s10, 10
    v_add_u32 v7, s10, v6
    global_load_dwordx4 v[80:83], v7, s[22:23] nt
    s_mov_b32 s11, 0
L_cr_17:
    ds_read_b32 v12, v5 offset:16368
    s_waitcnt lgkmcnt(0)
    v_subrev_u32 v12, s9, v12
    v_subrev_u32 v12, 4, v12
    v_cmp_lt_u32 vcc, 6, v12
    s_cbranch_vccz L_cr_17_ok
    s_sleep 1
    s_add_u32 s11, s11, 1
    s_cmp_lt_u32 s11, 2097152
    s_cbranch_scc1 L_cr_17
L_cr_17_ok:
    s_add_u32 s10, s18, 1
    s_and_b32 s10, s10, 63
    s_lshl_b32 s10, s10, 10
    v_add_u32 v7, s10, v6
    global_load_dwordx4 v[84:87], v7, s[22:23] nt
    s_mov_b32 s11, 0
L_cr_18:
    ds_read_b32 v12, v5 offset:16368
    s_waitcnt lgkmcnt(0)
    v_subrev_u32 v12, s9, v12
    v_subrev_u32 v12, 6, v12
    v_cmp_lt_u32 vcc, 4, v12
    s_cbranch_vccz L_cr_18_ok
    s_sleep 1
    s_add_u32 s11, s11, 1
    s_cmp_lt_u32 s11, 2097152
    s_cbranch_scc1 L_cr_18
L_cr_18_ok:
    s_add_u32 s10, s18, 2
    s_and_b32 s10, s10, 63
    s_lshl_b32 s10, s10, 10
    v_add_u32 v7, s10, v6
    global_load_dwordx4 v[88:91], v7, s[22:23] nt
    s_mov_b32 s11, 0
L_cr_19:
    ds_read_b32 v12, v5 offset:16368
    s_waitcnt lgkmcnt(0)
    v_subrev_u32 v12, s9, v12
    v_subrev_u32 v12, 8, v12
    v_cmp_lt_u32 vcc, 2, v12
    s_cbranch_vccz L_cr_19_ok
    s_sleep 1
    s_add_u32 s11, s11, 1
    s_cmp_lt_u32 s11, 2097152
    s_cbranch_scc1 L_cr_19
L_cr_19_ok:
    s_add_u32 s10, s18, 3
    s_and_b32 s10, s10, 63
    s_lshl_b32 s10, s10, 10
    v_add_u32 v7, s10, v6
    global_load_dwordx4 v[92:95], v7, s[22:23] nt
    s_mov_b32 s11, 0
L_cr_20:
    ds_read_b32 v12, v5 offset:16368
    s_waitcnt lgkmcnt(0)
    v_subrev_u32 v12, s9, v12
    v_subrev_u32 v12, 10, v12
    v_cmp_lt_u32 vcc, 0, v12
    s_cbranch_vccz L_cr_20_ok
    s_sleep 1
    s_add_u32 s11, s11, 1
    s_cmp_lt_u32 s11, 2097152
    s_cbranch_scc1 L_cr_20
L_cr_20_ok:
    s_add_u32 s10, s18, 4
    s_and_b32 s10, s10, 63
    s_lshl_b32 s10, s10, 10
    v_add_u32 v7, s10, v6
    global_load_dwordx4 v[96:99], v7, s[22:23] nt
    s_add_u32 s10, s18, 5
    s_and_b32 s10, s10, 63
    s_lshl_b32 s10, s10, 10
    v_add_u32 v7, s10, v6
    global_load_dwordx4 v[100:103], v7, s[22:23] nt
    s_waitcnt vmcnt(5)
    s_add_u32 s10, s18, 6
    s_and_b32 s10, s10, 63
    s_lshl_b32 s10, s10, 10
    v_add_u32 v7, s10, v6
    global_load_dwordx4 v[104:107], v7, s[22:23] nt
    s_waitcnt vmcnt(5)
    s_add_u32 s10, s18, 7
    s_and_b32 s10, s10, 63
    s_lshl_b32 s10, s10, 10
    v_add_u32 v7, s10, v6
    global_load_dwordx4 v[108:111], v7, s[22:23] nt
    s_waitcnt vmcnt(5)
    s_add_u32 s10, s18, 8
    s_and_b32 s10, s10, 63
    s_lshl_b32 s10, s10, 10
    v_add_u32 v7, s10, v6
    global_load_dwordx4 v[112:115], v7, s[22:23] nt
    s_waitcnt vmcnt(5)
    s_add_u32 s10, s18, 9
    s_and_b32 s10, s10, 63
    s_lshl_b32 s10, s10, 10
    v_add_u32 v7, s10, v6
    global_load_dwordx4 v[116:119], v7, s[22:23] nt
    s_waitcnt vmcnt(5)
    s_add_u32 s10, s18, 10
    s_and_b32 s10, s10, 63
    s_lshl_b32 s10, s10, 10
    v_add_u32 v7, s10, v6
    global_load_dwordx4 v[120:123], v7, s[22:23] nt
    s_waitcnt vmcnt(5)
    s_add_u32 s10, s18, 11
    s_and_b32 s10, s10, 63
    s_lshl_b32 s10, s10, 10
    v_add_u32 v7, s10, v6
    global_load_dwordx4 v[124:127], v7, s[22:23] nt
    s_waitcnt vmcnt(5)
    s_add_u32 s10, s18, 12
    s_and_b32 s10, s10, 63
    s_lshl_b32 s10, s10, 10
    v_add_u32 v7, s10, v6
    global_load_dwordx4 v[128:131], v7, s[22:23] nt
    s_add_u32 s10, s18, 13
    s_and_b32 s10, s10, 63
    s_lshl_b32 s10, s10, 10
    v_add_u32 v7, s10, v6
    global_load_dwordx4 v[132:135], v7, s[22:23] nt
    s_add_u32 s10, s18, 14
    s_and_b32 s10, s10, 63
    s_lshl_b32 s10, s10, 10
    v_add_u32 v7, s10, v6
    global_load_dwordx4 v[136:139], v7, s[22:23] nt
    s_add_u32 s10, s18, 15
    s_and_b32 s10, s10, 63
    s_lshl_b32 s10, s10, 10
    v_add_u32 v7, s10, v6
    global_load_dwordx4 v[140:143], v7, s[22:23] nt
    s_setprio 2
    s_mov_b32 s11, 0
L_l1_21:
    ds_read_b32 v12, v5 offset:16352
    s_waitcnt lgkmcnt(0)
    v_cmp_ne_u32 vcc, s9, v12
    s_cbranch_vccz L_l1_21_ok
    s_sleep 1
    s_add_u32 s11, s11, 1
    s_cmp_lt_u32 s11, 2097152
    s_cbranch_scc1 L_l1_21
L_l1_21_ok:
    ds_read_b128 v[20:23], v8 offset:11520
    ds_read_b128 v[24:27], v8 offset:11536
    ds_read_b128 v[28:31], v8 offset:11552
    ds_read_b128 v[32:35], v8 offset:11568
    s_waitcnt lgkmcnt(0)
    v_and_b32 v40, v20, v10
    v_and_b32 v41, v20, v11
    v_and_b32 v42, v21, v10
    v_and_b32 v43, v21, v11
    v_and_b32 v44, v22, v10
    v_and_b32 v45, v22, v11
    v_and_b32 v46, v23, v10
    v_and_b32 v47, v23, v11
    v_and_b32 v48, v24, v10
    v_and_b32 v49, v24, v11
    v_and_b32 v50, v25, v10
    v_and_b32 v51, v25, v11
    v_and_b32 v52, v26, v10
    v_and_b32 v53, v26, v11
    v_and_b32 v54, v27, v10
    v_and_b32 v55, v27, v11
    v_and_b32 v56, v28, v10
    v_and_b32 v57, v28, v11
    v_and_b32 v58, v29, v10
    v_and_b32 v59, v29, v11
    v_and_b32 v60, v30, v10
    v_and_b32 v61, v30, v11
    v_and_b32 v62, v31, v10
    v_and_b32 v63, v31, v11
    v_and_b32 v64, v32, v10
    v_and_b32 v65, v32, v11
    v_and_b32 v66, v33, v10
    v_and_b32 v67, v33, v11
    v_and_b32 v68, v34, v10
    v_and_b32 v69, v34, v11
    v_and_b32 v70, v35, v10
    v_and_b32 v71, v35, v11
    s_waitcnt vmcnt(15)
    v_mfma_f32_16x16x16_bf16 v[12:15], v[80:81], v[40:41], 0
    v_mfma_f32_16x16x16_bf16 v[16:19], v[82:83], v[40:41], 0
    s_waitcnt vmcnt(14)
    v_mfma_f32_16x16x16_bf16 v[12:15], v[84:85], v[42:43], v[12:15]
    v_mfma_f32_16x16x16_bf16 v[16:19], v[86:87], v[42:43], v[16:19]
    s_waitcnt vmcnt(13)
    v_mfma_f32_16x16x16_bf16 v[12:15], v[88:89], v[44:45], v[12:15]
    v_mfma_f32_16x16x16_bf16 v[16:19], v[90:91], v[44:45], v[16:19]
    s_waitcnt vmcnt(12)
    v_mfma_f32_16x16x16_bf16 v[12:15], v[92:93], v[46:47], v[12:15]
    v_mfma_f32_16x16x16_bf16 v[16:19], v[94:95], v[46:47], v[16:19]
    s_waitcnt vmcnt(11)
    v_mfma_f32_16x16x16_bf16 v[12:15], v[96:97], v[48:49], v[12:15]
    v_mfma_f32_16x16x16_bf16 v[16:19], v[98:99], v[48:49], v[16:19]
    s_waitcnt vmcnt(10)
    v_mfma_f32_16x16x16_bf16 v[12:15], v[100:101], v[50:51], v[12:15]
    v_mfma_f32_16x16x16_bf16 v[16:19], v[102:103], v[50:51], v[16:19]
    s_waitcnt vmcnt(9)
    v_mfma_f32_16x16x16_bf16 v[12:15], v[104:105], v[52:53], v[12:15]
    v_mfma_f32_16x16x16_bf16 v[16:19], v[106:107], v[52:53], v[16:19]
    s_waitcnt vmcnt(8)
    v_mfma_f32_16x16x16_bf16 v[12:15], v[108:109], v[54:55], v[12:15]
    v_mfma_f32_16x16x16_bf16 v[16:19], v[110:111], v[54:55], v[16:19]
    s_waitcnt vmcnt(7)
    v_mfma_f32_16x16x16_bf16 v[12:15], v[112:113], v[56:57], v[12:15]
    v_mfma_f32_16x16x16_bf16 v[16:19], v[114:115], v[56:57], v[16:19]
    s_waitcnt vmcnt(6)
    v_mfma_f32_16x16x16_bf16 v[12:15], v[116:117], v[58:59], v[12:15]
    v_mfma_f32_16x16x16_bf16 v[16:19], v[118:119], v[58:59], v[16:19]
    s_waitcnt vmcnt(5)
    v_mfma_f32_16x16x16_bf16 v[12:15], v[120:121], v[60:61], v[12:15]
    v_mfma_f32_16x16x16_bf16 v[16:19], v[122:123], v[60:61], v[16:19]
    s_waitcnt vmcnt(4)
    v_mfma_f32_16x16x16_bf16 v[12:15], v[124:125], v[62:63], v[12:15]
    v_mfma_f32_16x16x16_bf16 v[16:19], v[126:127], v[62:63], v[16:19]
    s_waitcnt vmcnt(3)
    v_mfma_f32_16x16x16_bf16 v[12:15], v[128:129], v[64:65], v[12:15]
    v_mfma_f32_16x16x16_bf16 v[16:19], v[130:131], v[64:65], v[16:19]
    s_waitcnt vmcnt(2)
    ds_write_b32 v5, v9 offset:16384
    v_mfma_f32_16x16x16_bf16 v[12:15], v[132:133], v[66:67], v[12:15]
    v_mfma_f32_16x16x16_bf16 v[16:19], v[134:135], v[66:67], v[16:19]
    s_waitcnt vmcnt(1)
    v_mfma_f32_16x16x16_bf16 v[12:15], v[136:137], v[68:69], v[12:15]
    v_mfma_f32_16x16x16_bf16 v[16:19], v[138:139], v[68:69], v[16:19]
    s_waitcnt vmcnt(0)
    v_mfma_f32_16x16x16_bf16 v[12:15], v[140:141], v[70:71], v[12:15]
    v_mfma_f32_16x16x16_bf16 v[16:19], v[142:143], v[70:71], v[16:19]
    s_nop 6
    ds_write_b128 v153, v[12:15] offset:17088
    ds_write_b128 v153, v[16:19] offset:18112
    ds_write_b32 v5, v9 offset:16448
    ds_write_b32 v5, v9 offset:16624
    ds_write_b32 v5, v9 offset:16640
    s_cmp_lt_u32 s6, 2
    s_cbranch_scc0 L_V_end
    s_mov_b32 s11, 0
L_ls_22:
    ds_read_b128 v[32:35], v145 offset:16464
    s_waitcnt lgkmcnt(0)
    v_xor_b32 v32, s9, v32
    v_xor_b32 v33, s9, v33
    v_xor_b32 v34, s9, v34
    v_xor_b32 v35, s9, v35
    v_or3_b32 v32, v32, v33, v34
    v_or_b32 v32, v32, v35
    v_cmp_ne_u32 vcc, 0, v32
    s_cbranch_vccz L_ls_22_ok
    s_add_u32 s11, s11, 1
    s_cmp_lt_u32 s11, 2097152
    s_cbranch_scc1 L_ls_22
L_ls_22_ok:
    ds_read_b128 v[32:35], v146 offset:25344
    ds_read_b128 v[36:39], v146 offset:27392
    ds_read_b128 v[40:43], v146 offset:29440
    ds_read_b128 v[44:47], v146 offset:31488
    s_waitcnt lgkmcnt(0)
    v_pk_add_f32 v[32:33], v[32:33], v[40:41]
    v_pk_add_f32 v[34:35], v[34:35], v[42:43]
    v_pk_add_f32 v[36:37], v[36:37], v[44:45]
    v_pk_add_f32 v[38:39], v[38:39], v[46:47]
    v_pk_add_f32 v[32:33], v[32:33], v[36:37]
    v_pk_add_f32 v[34:35], v[34:35], v[38:39]
    v_and_or_b32 v32, v32, v154, s64
    v_and_or_b32 v33, v33, v154, s65
    v_and_or_b32 v34, v34, v154, s66
    v_and_or_b32 v35, v35, v154, s67
    v_add_u32 v147, 0x800000, v147
    global_store_dwordx4 v147, v[32:35], s[20:21] sc1
    v_lshlrev_b32 v8, 2, v0
    v_add_u32 v40, v8, v145
    s_mov_b64 exec, 0xff
    ds_write_b32 v40, v4 offset:16464
    s_mov_b64 exec, -1
L_V_end:
L_end:
    s_endpgm
L_code_end:
.section .rodata,"a"
.p2align 6
.amdhsa_kernel recurrent_scan__sliding_block_cached__mixer_channel_mlp__decode_kernel
  .amdhsa_next_free_vgpr 168
  .amdhsa_next_free_sgpr 102
  .amdhsa_accum_offset 168
  .amdhsa_group_segment_fixed_size 0
  .amdhsa_kernarg_size 104
  .amdhsa_user_sgpr_count 2
  .amdhsa_user_sgpr_kernarg_segment_ptr 1
  .amdhsa_system_sgpr_workgroup_id_x 1
.end_amdhsa_kernel
```
